```python
import torch

def _softmax(x, axis=-1):
    return torch.softmax(x, dim=axis)
def _gelu(x):
    return torch.nn.functional.gelu(x, approximate="tanh")
def _silu(x):
    return torch.nn.functional.silu(x)
def _sigmoid(x):
    return torch.sigmoid(x)
def _layernorm(x, axis=-1, eps=1e-5):
    m = x.mean(dim=axis, keepdim=True)
    v = x.var(dim=axis, keepdim=True, unbiased=False)
    return (x - m) / torch.sqrt(v + eps)
def _scatter_add(tgt, idx, src, axis=0):
    return tgt.clone().index_add_(axis, idx, src)
def _segment_sum(src, seg, n):
    out = torch.zeros((n,) + src.shape[1:], dtype=src.dtype)
    return out.index_add_(0, seg, src)
def _pad(x, pw):
    flat = tuple(v for pair in reversed(pw) for v in pair)
    return torch.nn.functional.pad(x, flat)

kernel_name = 'parallel_sum__ssm_conv_s4d__glu_gated_bilinear__prompt'

def setup_inputs():

    _w = (lambda a: (lambda t: t.to(torch.bfloat16) if t.is_floating_point() else t)(torch.as_tensor(a)))
    def _A_setup():
        Bsz, L, D, N = 1, 2048, 512, 128
        return {
            "u": _w((lambda *s: torch.randn(*s, dtype=torch.bfloat16) * 0.05)(Bsz, L, D)),
            "log_A_real": _w((lambda *s: torch.randn(*s, dtype=torch.bfloat16) * 3.2)(D, N) * 0.5),
            "A_imag": _w((lambda *s: torch.randn(*s, dtype=torch.bfloat16) * 0.05)(D, N) * 3.14),
            "C_real": _w((lambda *s: torch.randn(*s, dtype=torch.bfloat16) * 0.1)(D, N) / N ** 0.5),
            "C_imag": _w((lambda *s: torch.randn(*s, dtype=torch.bfloat16) * 0.2)(D, N) / N ** 0.5),
            "log_dt": _w((lambda *s: torch.randn(*s, dtype=torch.bfloat16) * 0.05)(D) * 0.5 - 4.0),
            "D_skip": _w((lambda *s: torch.randn(*s, dtype=torch.bfloat16) * 0.05)(D)),
        }
    _A_in = _A_setup()

    def _B_setup():
        B, S, D, F = 1, 2048, 512, 1376
        return {
            "x": _w((lambda *s: torch.randn(*s, dtype=torch.bfloat16) * 0.05)(B, S, D)),
            "w_gate": _w((lambda *s: torch.randn(*s, dtype=torch.bfloat16) * 0.4)(D, F) * (D ** -0.5)),
            "w_up": _w((lambda *s: torch.randn(*s, dtype=torch.bfloat16) * 0.4)(D, F) * (D ** -0.5)),
            "w_down": _w((lambda *s: torch.randn(*s, dtype=torch.bfloat16) * 0.4)(F, D) * (F ** -0.5)),
        }
    _B_in = _B_setup()

    return {
        "A_u": _A_in["u"],
        "A_log_A_real": _A_in["log_A_real"],
        "A_A_imag": _A_in["A_imag"],
        "A_C_real": _A_in["C_real"],
        "A_C_imag": _A_in["C_imag"],
        "A_log_dt": _A_in["log_dt"],
        "A_D_skip": _A_in["D_skip"],
        "B_x": _B_in["x"],
        "B_w_gate": _B_in["w_gate"],
        "B_w_up": _B_in["w_up"],
        "B_w_down": _B_in["w_down"],
    }

def reference(A_u, A_log_A_real, A_A_imag, A_C_real, A_C_imag, A_log_dt, A_D_skip, B_x, B_w_gate, B_w_up, B_w_down):
    def _A_ref(u, log_A_real, A_imag, C_real, C_imag, log_dt, D_skip):
        L = u.shape[1]
        dt = torch.exp(log_dt)
        A = -torch.exp(log_A_real) + 1j * A_imag
        C = (C_real + 1j * C_imag) * dt[:, None]
        pos = (lambda x, dt: x.to(dt))(torch.arange(L), log_dt.dtype)
        P = torch.exp((A * dt[:, None])[:, :, None] * pos[None, None, :])
        K = 2.0 * torch.einsum("dn,dnl->dl", C, P).real
        L2 = 2 * L
        u_t = (lambda x, *d: x.permute(*d))(u, 0, 2, 1)
        Kf = (lambda x, *a, **k: torch.fft.rfft(x.float(), *a, **k))(K, L2)
        Uf = (lambda x, *a, **k: torch.fft.rfft(x.float(), *a, **k))(u_t, L2)
        y = (lambda x, *a, **k: torch.fft.irfft(x, *a, **k).to(torch.bfloat16))(Uf * Kf[None, :, :], L2)[:, :, :L]
        y = (lambda x, *d: x.permute(*d))(y, 0, 2, 1)
        return y + u * D_skip[None, None, :]

    def _B_ref(x, w_gate, w_up, w_down):
        g = torch.einsum("bsd,df->bsf", x, w_gate)
        u = torch.einsum("bsd,df->bsf", x, w_up)
        h = g * u
        return torch.einsum("bsf,fd->bsd", h, w_down)

    x = A_u
    xn = _layernorm(x, axis=-1)
    return x + _A_ref(xn, A_log_A_real, A_A_imag, A_C_real, A_C_imag, A_log_dt, A_D_skip) + _B_ref(xn, B_w_gate, B_w_up, B_w_down)
```

```asm
; @launch grid=(512,1,1) block=(256,1,1) lds=81920
.amdgcn_target "amdgcn-amd-amdhsa--gfx950"
.text
.globl parallel_sum__ssm_conv_s4d__glu_gated_bilinear__prompt_kernel
.p2align 8
.type parallel_sum__ssm_conv_s4d__glu_gated_bilinear__prompt_kernel,@function
parallel_sum__ssm_conv_s4d__glu_gated_bilinear__prompt_kernel:
  s_cmp_ge_u32 s2, 512
  s_cbranch_scc1 L_exit
  s_load_dwordx16 s[16:31], s[0:1], 0
  s_load_dwordx8 s[32:39], s[0:1], 64
  s_load_dwordx4 s[40:43], s[0:1], 96
  s_mov_b32 s44, 0x3f803f80
  v_lshrrev_b32 v2, 6, v0
  v_and_b32 v1, 63, v0
  v_readfirstlane_b32 s45, v2
  s_cmp_ge_u32 s2, 256
  s_cbranch_scc1 L_ssm
  s_mov_b32 s46, s2
  s_and_b32 s3, s46, 7
  s_lshr_b32 s4, s46, 3
  s_lshr_b32 s5, s3, 1
  s_lshl_b32 s5, s5, 2
  s_and_b32 s6, s4, 3
  s_add_u32 s47, s5, s6
  s_and_b32 s5, s3, 1
  s_lshl_b32 s5, s5, 3
  s_lshr_b32 s6, s4, 2
  s_add_u32 s48, s5, s6
  s_lshl_b32 s5, s3, 2
  s_and_b32 s6, s4, 3
  s_add_u32 s50, s5, s6
  s_lshr_b32 s51, s4, 2
  s_and_b32 s60, s45, 1
  s_lshr_b32 s61, s45, 1
  s_setprio 2
  v_lshrrev_b32 v26, 3, v1
  v_and_b32 v27, 7, v1
  v_lshrrev_b32 v28, 1, v26
  v_xor_b32 v29, v27, v28
  v_lshlrev_b32 v30, 10, v26
  s_lshl_b32 s3, s45, 15
  v_add_u32 v30, s3, v30
  v_xor_b32 v31, 0, v29
  v_lshl_add_u32 v11, v31, 4, v30
  v_xor_b32 v31, 4, v29
  v_lshl_add_u32 v12, v31, 4, v30
  v_add_u32 v12, 8192, v12
  v_xor_b32 v31, 0, v29
  v_lshl_add_u32 v13, v31, 4, v30
  v_add_u32 v13, 16384, v13
  v_xor_b32 v31, 4, v29
  v_lshl_add_u32 v14, v31, 4, v30
  v_add_u32 v14, 24576, v14
  s_lshl_b32 s3, s60, 1
  s_mul_i32 s4, s61, 44032
  v_add_u32 v26, 0, v1
  v_mul_u32_u24 v27, 0x5556, v26
  v_lshrrev_b32 v27, 18, v27
  v_mul_u32_u24 v28, 12, v27
  v_sub_u32 v28, v26, v28
  v_xor_b32 v28, s3, v28
  v_lshlrev_b32 v28, 4, v28
  v_mul_u32_u24 v27, 2752, v27
  v_add3_u32 v15, v27, v28, s4
  v_add_u32 v26, 64, v1
  v_mul_u32_u24 v27, 0x5556, v26
  v_lshrrev_b32 v27, 18, v27
  v_mul_u32_u24 v28, 12, v27
  v_sub_u32 v28, v26, v28
  v_xor_b32 v28, s3, v28
  v_lshlrev_b32 v28, 4, v28
  v_mul_u32_u24 v27, 2752, v27
  v_add3_u32 v16, v27, v28, s4
  v_add_u32 v26, 128, v1
  v_mul_u32_u24 v27, 0x5556, v26
  v_lshrrev_b32 v27, 18, v27
  v_mul_u32_u24 v28, 12, v27
  v_sub_u32 v28, v26, v28
  v_xor_b32 v28, s3, v28
  v_lshlrev_b32 v28, 4, v28
  v_mul_u32_u24 v27, 2752, v27
  v_add3_u32 v17, v27, v28, s4
  s_lshr_b32 s5, s47, 2
  s_lshl_b32 s5, s5, 1
  s_add_u32 s5, s5, s48
  s_and_b32 s5, s5, 7
  s_lshl_b32 s62, s5, 7
  s_mul_i32 s63, s5, 176128
  s_lshl_b32 s64, s45, 12
  s_add_u32 s64, s64, 49152
  s_mul_i32 s65, s61, 6144
  s_mul_i32 s3, s60, 3072
  s_add_u32 s65, s65, s3
  s_waitcnt lgkmcnt(0)
  s_lshl_b32 s3, s47, 17
  s_add_u32 s52, s16, s3
  s_addc_u32 s53, s17, 0
  s_and_b32 s53, s53, 0xffff
  s_mov_b32 s54, 0x20000
  s_mov_b32 s55, 0x20000
  s_cmp_eq_u32 s60, 0
  s_cselect_b32 s56, s32, s34
  s_cselect_b32 s57, s33, s35
  s_mul_i32 s3, s48, 192
  s_add_u32 s56, s56, s3
  s_addc_u32 s57, s57, 0
  s_and_b32 s57, s57, 0xffff
  s_sub_u32 s58, 1409024, s3
  s_mov_b32 s59, 0x20000
  s_cmp_ge_u32 s48, 15
  s_cbranch_scc1 L_idle
  s_add_u32 m0, s65, 0
  s_nop 0
  buffer_load_dwordx4 v15, s[56:59], s63 offen  lds
  s_add_u32 m0, s65, 1024
  s_nop 0
  buffer_load_dwordx4 v16, s[56:59], s63 offen  lds
  s_add_u32 m0, s65, 2048
  s_nop 0
  buffer_load_dwordx4 v17, s[56:59], s63 offen  lds
  s_add_u32 s63, s63, 88064
  s_cmp_ge_u32 s63, 1409024
  s_cselect_b32 s3, 1409024, 0
  s_sub_u32 s63, s63, s3
  s_add_u32 m0, s64, 0
  s_nop 0
  buffer_load_dwordx4 v11, s[52:55], s62 offen  lds
  s_add_u32 m0, s64, 1024
  s_nop 0
  buffer_load_dwordx4 v12, s[52:55], s62 offen  lds
  s_add_u32 m0, s64, 2048
  s_nop 0
  buffer_load_dwordx4 v13, s[52:55], s62 offen  lds
  s_add_u32 m0, s64, 3072
  s_nop 0
  buffer_load_dwordx4 v14, s[52:55], s62 offen  lds
  s_add_u32 s62, s62, 128
  s_and_b32 s62, s62, 1023
  s_add_u32 m0, s65, 12288
  s_nop 0
  buffer_load_dwordx4 v15, s[56:59], s63 offen  lds
  s_add_u32 m0, s65, 13312
  s_nop 0
  buffer_load_dwordx4 v16, s[56:59], s63 offen  lds
  s_add_u32 m0, s65, 14336
  s_nop 0
  buffer_load_dwordx4 v17, s[56:59], s63 offen  lds
  s_add_u32 s63, s63, 88064
  s_cmp_ge_u32 s63, 1409024
  s_cselect_b32 s3, 1409024, 0
  s_sub_u32 s63, s63, s3
  v_mov_b32 v26, 0
  global_load_dword v25, v26, s[42:43] sc1
  s_lshr_b32 s3, s46, 3
  s_mul_i32 s3, s3, 344
  s_mul_i32 s4, s45, 86
  s_add_u32 s3, s3, s4
  s_lshl_b32 s3, s3, 7
  v_lshlrev_b32 v158, 7, v1
  v_add_u32 v158, s3, v158
  s_lshr_b32 s3, s46, 3
  s_mul_i32 s4, s3, 10923
  s_lshr_b32 s4, s4, 16
  s_mul_i32 s4, s4, 6
  s_sub_u32 s12, s3, s4
  s_add_u32 s66, s42, 0x500000
  s_addc_u32 s67, s43, 0
  s_lshl_b32 s3, s47, 2
  s_lshl_b32 s4, s61, 1
  s_add_u32 s3, s3, s4
  s_mul_i32 s3, s3, 86
  s_mul_i32 s4, s48, 6
  s_mul_i32 s5, s60, 3
  s_add_u32 s11, s4, s5
  s_add_u32 s3, s3, s11
  s_lshl_b32 s3, s3, 10
  v_lshlrev_b32 v24, 4, v1
  v_add_u32 v24, s3, v24
  v_bfe_u32 v26, v1, 4, 1
  v_lshrrev_b32 v27, 5, v1
  v_bfe_u32 v28, v1, 2, 2
  v_lshl_add_u32 v28, v27, 3, v28
  v_mul_u32_u24 v28, 192, v28
  v_mul_u32_u24 v29, 3072, v26
  v_add_u32 v28, v28, v29
  v_bfe_u32 v29, v1, 1, 1
  v_lshlrev_b32 v29, 4, v29
  v_and_b32 v30, 1, v1
  v_lshlrev_b32 v30, 3, v30
  v_add3_u32 v28, v28, v29, v30
  s_mul_i32 s3, s60, 3
  s_add_u32 s4, s3, 0
  v_xor_b32 v29, s4, v26
  v_lshl_add_u32 v4, v29, 5, v28
  s_add_u32 s4, s3, 1
  v_xor_b32 v29, s4, v26
  v_lshl_add_u32 v5, v29, 5, v28
  s_add_u32 s4, s3, 2
  v_xor_b32 v29, s4, v26
  v_lshl_add_u32 v6, v29, 5, v28
  v_and_b32 v26, 31, v1
  v_bfe_u32 v28, v26, 1, 3
  s_lshl_b32 s3, s61, 13
  s_add_u32 s3, s3, 49152
  v_lshlrev_b32 v29, 7, v26
  v_add_u32 v29, s3, v29
  v_add_u32 v30, 0, v27
  v_xor_b32 v30, v30, v28
  v_lshl_add_u32 v7, v30, 4, v29
  v_add_u32 v30, 2, v27
  v_xor_b32 v30, v30, v28
  v_lshl_add_u32 v8, v30, 4, v29
  v_add_u32 v30, 4, v27
  v_xor_b32 v30, v30, v28
  v_lshl_add_u32 v9, v30, 4, v29
  v_add_u32 v30, 6, v27
  v_xor_b32 v30, v30, v28
  v_lshl_add_u32 v10, v30, 4, v29
  v_lshrrev_b32 v26, 4, v1
  v_xor_b32 v26, v26, v1
  v_and_b32 v26, 1, v26
  v_cmp_eq_u32 vcc, 0, v26
  v_mov_b32 v26, s44
  s_nop 0
  v_cndmask_b32 v120, 0, v26, vcc
  v_mov_b32 v121, v120
  v_mov_b32 v122, v120
  v_mov_b32 v123, v120
  v_mov_b32 v124, s44
  v_mov_b32 v125, s44
  v_mov_b32 v126, s44
  v_mov_b32 v127, s44
  s_and_b32 s3, s47, 3
  s_lshl_b32 s3, s3, 1
  s_add_u32 s10, s3, s61
  s_lshl_b32 s3, s47, 7
  s_lshl_b32 s4, s61, 6
  s_add_u32 s3, s3, s4
  s_lshl_b32 s3, s3, 3
  s_add_u32 s3, s3, 0x8000
  v_and_b32 v26, 31, v1
  v_lshl_add_u32 v2, v26, 3, s3
  s_lshl_b32 s3, s11, 10
  s_add_u32 s3, s3, 0x10000
  v_lshl_add_u32 v3, v26, 5, s3
  v_lshrrev_b32 v27, 5, v1
  v_lshl_add_u32 v3, v27, 4, v3
  s_waitcnt vmcnt(4)
  s_barrier
  ds_read_b128 v[56:59], v7 offset:0
  ds_read_b128 v[60:63], v7 offset:4096
  ds_read_b64_tr_b16 v[32:33], v4 offset:0
  ds_read_b64_tr_b16 v[34:35], v4 offset:768
  ds_read_b64_tr_b16 v[36:37], v5 offset:0
  ds_read_b64_tr_b16 v[38:39], v5 offset:768
  ds_read_b64_tr_b16 v[40:41], v6 offset:0
  ds_read_b64_tr_b16 v[42:43], v6 offset:768
  s_waitcnt lgkmcnt(0)
  v_mfma_f32_32x32x16_bf16 v[160:175], v[32:35], v[56:59], 0
  ds_read_b128 v[64:67], v8 offset:0
  ds_read_b128 v[68:71], v8 offset:4096
  s_add_u32 m0, s65, 24576
  s_nop 0
  buffer_load_dwordx4 v15, s[56:59], s63 offen  lds
  s_add_u32 m0, s65, 25600
  s_nop 0
  buffer_load_dwordx4 v16, s[56:59], s63 offen  lds
  v_mfma_f32_32x32x16_bf16 v[176:191], v[32:35], v[60:63], 0
  ds_read_b64_tr_b16 v[44:45], v4 offset:6144
  ds_read_b64_tr_b16 v[46:47], v4 offset:6912
  s_add_u32 m0, s65, 26624
  s_nop 0
  buffer_load_dwordx4 v17, s[56:59], s63 offen  lds
  s_add_u32 s63, s63, 88064
  s_cmp_ge_u32 s63, 1409024
  s_cselect_b32 s3, 1409024, 0
  s_sub_u32 s63, s63, s3
  s_add_u32 m0, s64, 16384
  s_nop 0
  buffer_load_dwordx4 v11, s[52:55], s62 offen  lds
  v_mfma_f32_32x32x16_bf16 v[192:207], v[36:39], v[56:59], 0
  ds_read_b64_tr_b16 v[48:49], v5 offset:6144
  ds_read_b64_tr_b16 v[50:51], v5 offset:6912
  s_add_u32 m0, s64, 17408
  s_nop 0
  buffer_load_dwordx4 v12, s[52:55], s62 offen  lds
  v_mfma_f32_32x32x16_bf16 v[208:223], v[36:39], v[60:63], 0
  ds_read_b64_tr_b16 v[52:53], v6 offset:6144
  ds_read_b64_tr_b16 v[54:55], v6 offset:6912
  s_add_u32 m0, s64, 18432
  s_nop 0
  buffer_load_dwordx4 v13, s[52:55], s62 offen  lds
  s_add_u32 m0, s64, 19456
  s_nop 0
  buffer_load_dwordx4 v14, s[52:55], s62 offen  lds
  s_add_u32 s62, s62, 128
  s_and_b32 s62, s62, 1023
  v_mfma_f32_32x32x16_bf16 v[224:239], v[40:43], v[56:59], 0
  ds_read_b128 v[72:75], v9 offset:0
  ds_read_b128 v[76:79], v9 offset:4096
  s_add_u32 m0, s65, 36864
  s_nop 0
  buffer_load_dwordx4 v15, s[56:59], s63 offen  lds
  s_add_u32 m0, s65, 37888
  s_nop 0
  buffer_load_dwordx4 v16, s[56:59], s63 offen  lds
  v_mfma_f32_32x32x16_bf16 v[240:255], v[40:43], v[60:63], 0
  ds_read_b128 v[80:83], v10 offset:0
  ds_read_b128 v[84:87], v10 offset:4096
  s_add_u32 m0, s65, 38912
  s_nop 0
  buffer_load_dwordx4 v17, s[56:59], s63 offen  lds
  s_add_u32 s63, s63, 88064
  s_cmp_ge_u32 s63, 1409024
  s_cselect_b32 s3, 1409024, 0
  s_sub_u32 s63, s63, s3
  s_cmp_eq_u32 s10, 0
  s_cbranch_scc0 L_cs0_0
  v_mfma_f32_16x16x32_bf16 v[128:131], v[120:123], v[32:35], 0
L_cs0_0:
  s_cmp_eq_u32 s10, 1
  s_cbranch_scc0 L_cs0_1
  v_mfma_f32_16x16x32_bf16 v[128:131], v[120:123], v[36:39], 0
L_cs0_1:
  s_cmp_eq_u32 s10, 2
  s_cbranch_scc0 L_cs0_2
  v_mfma_f32_16x16x32_bf16 v[128:131], v[120:123], v[40:43], 0
L_cs0_2:
  s_waitcnt lgkmcnt(0)
  v_mfma_f32_32x32x16_bf16 v[160:175], v[44:47], v[64:67], v[160:175]
  s_waitcnt vmcnt(11)
  s_barrier
  ds_read_b64_tr_b16 v[32:33], v4 offset:12288
  ds_read_b64_tr_b16 v[34:35], v4 offset:13056
  v_mfma_f32_32x32x16_bf16 v[176:191], v[44:47], v[68:71], v[176:191]
  ds_read_b64_tr_b16 v[36:37], v5 offset:12288
  ds_read_b64_tr_b16 v[38:39], v5 offset:13056
  s_add_u32 m0, s65, 0
  s_nop 0
  buffer_load_dwordx4 v15, s[56:59], s63 offen  lds
  v_mfma_f32_32x32x16_bf16 v[192:207], v[48:51], v[64:67], v[192:207]
  ds_read_b64_tr_b16 v[40:41], v6 offset:12288
  ds_read_b64_tr_b16 v[42:43], v6 offset:13056
  s_add_u32 m0, s65, 1024
  s_nop 0
  buffer_load_dwordx4 v16, s[56:59], s63 offen  lds
  v_mfma_f32_32x32x16_bf16 v[208:223], v[48:51], v[68:71], v[208:223]
  s_add_u32 m0, s65, 2048
  s_nop 0
  buffer_load_dwordx4 v17, s[56:59], s63 offen  lds
  s_add_u32 s63, s63, 88064
  s_cmp_ge_u32 s63, 1409024
  s_cselect_b32 s3, 1409024, 0
  s_sub_u32 s63, s63, s3
  v_mfma_f32_32x32x16_bf16 v[224:239], v[52:55], v[64:67], v[224:239]
  s_add_u32 m0, s64, 0
  s_nop 0
  buffer_load_dwordx4 v11, s[52:55], s62 offen  lds
  v_mfma_f32_32x32x16_bf16 v[240:255], v[52:55], v[68:71], v[240:255]
  s_cmp_eq_u32 s10, 0
  s_cbranch_scc0 L_cs1_0
  v_mfma_f32_16x16x32_bf16 v[128:131], v[120:123], v[44:47], v[128:131]
L_cs1_0:
  s_cmp_eq_u32 s10, 1
  s_cbranch_scc0 L_cs1_1
  v_mfma_f32_16x16x32_bf16 v[128:131], v[120:123], v[48:51], v[128:131]
L_cs1_1:
  s_cmp_eq_u32 s10, 2
  s_cbranch_scc0 L_cs1_2
  v_mfma_f32_16x16x32_bf16 v[128:131], v[120:123], v[52:55], v[128:131]
L_cs1_2:
  s_waitcnt lgkmcnt(0)
  v_mfma_f32_32x32x16_bf16 v[160:175], v[32:35], v[72:75], v[160:175]
  ds_read_b64_tr_b16 v[44:45], v4 offset:18432
  ds_read_b64_tr_b16 v[46:47], v4 offset:19200
  s_add_u32 m0, s64, 1024
  s_nop 0
  buffer_load_dwordx4 v12, s[52:55], s62 offen  lds
  v_mfma_f32_32x32x16_bf16 v[176:191], v[32:35], v[76:79], v[176:191]
  ds_read_b64_tr_b16 v[48:49], v5 offset:18432
  ds_read_b64_tr_b16 v[50:51], v5 offset:19200
  v_mfma_f32_32x32x16_bf16 v[192:207], v[36:39], v[72:75], v[192:207]
  ds_read_b64_tr_b16 v[52:53], v6 offset:18432
  ds_read_b64_tr_b16 v[54:55], v6 offset:19200
  s_add_u32 m0, s64, 2048
  s_nop 0
  buffer_load_dwordx4 v13, s[52:55], s62 offen  lds
  v_mfma_f32_32x32x16_bf16 v[208:223], v[36:39], v[76:79], v[208:223]
  v_mfma_f32_32x32x16_bf16 v[224:239], v[40:43], v[72:75], v[224:239]
  s_add_u32 m0, s64, 3072
  s_nop 0
  buffer_load_dwordx4 v14, s[52:55], s62 offen  lds
  s_add_u32 s62, s62, 128
  s_and_b32 s62, s62, 1023
  v_mfma_f32_32x32x16_bf16 v[240:255], v[40:43], v[76:79], v[240:255]
  s_cmp_eq_u32 s10, 0
  s_cbranch_scc0 L_cs2_0
  v_mfma_f32_16x16x32_bf16 v[128:131], v[120:123], v[32:35], v[128:131]
L_cs2_0:
  s_cmp_eq_u32 s10, 1
  s_cbranch_scc0 L_cs2_1
  v_mfma_f32_16x16x32_bf16 v[128:131], v[120:123], v[36:39], v[128:131]
L_cs2_1:
  s_cmp_eq_u32 s10, 2
  s_cbranch_scc0 L_cs2_2
  v_mfma_f32_16x16x32_bf16 v[128:131], v[120:123], v[40:43], v[128:131]
L_cs2_2:
  s_waitcnt lgkmcnt(0)
  v_mfma_f32_32x32x16_bf16 v[160:175], v[44:47], v[80:83], v[160:175]
  s_waitcnt vmcnt(10)
  s_barrier
  ds_read_b64_tr_b16 v[32:33], v4 offset:24576
  ds_read_b64_tr_b16 v[34:35], v4 offset:25344
  v_mfma_f32_32x32x16_bf16 v[176:191], v[44:47], v[84:87], v[176:191]
  ds_read_b64_tr_b16 v[36:37], v5 offset:24576
  ds_read_b64_tr_b16 v[38:39], v5 offset:25344
  s_add_u32 m0, s65, 12288
  s_nop 0
  buffer_load_dwordx4 v15, s[56:59], s63 offen  lds
  v_mfma_f32_32x32x16_bf16 v[192:207], v[48:51], v[80:83], v[192:207]
  ds_read_b64_tr_b16 v[40:41], v6 offset:24576
  ds_read_b64_tr_b16 v[42:43], v6 offset:25344
  v_mfma_f32_32x32x16_bf16 v[208:223], v[48:51], v[84:87], v[208:223]
  ds_read_b128 v[88:91], v7 offset:16384
  ds_read_b128 v[92:95], v7 offset:20480
  s_add_u32 m0, s65, 13312
  s_nop 0
  buffer_load_dwordx4 v16, s[56:59], s63 offen  lds
  v_mfma_f32_32x32x16_bf16 v[224:239], v[52:55], v[80:83], v[224:239]
  v_mfma_f32_32x32x16_bf16 v[240:255], v[52:55], v[84:87], v[240:255]
  s_cmp_eq_u32 s10, 0
  s_cbranch_scc0 L_cs3_0
  v_mfma_f32_16x16x32_bf16 v[128:131], v[120:123], v[44:47], v[128:131]
L_cs3_0:
  s_cmp_eq_u32 s10, 1
  s_cbranch_scc0 L_cs3_1
  v_mfma_f32_16x16x32_bf16 v[128:131], v[120:123], v[48:51], v[128:131]
L_cs3_1:
  s_cmp_eq_u32 s10, 2
  s_cbranch_scc0 L_cs3_2
  v_mfma_f32_16x16x32_bf16 v[128:131], v[120:123], v[52:55], v[128:131]
L_cs3_2:
  s_waitcnt lgkmcnt(0)
  v_mfma_f32_32x32x16_bf16 v[160:175], v[32:35], v[88:91], v[160:175]
  ds_read_b128 v[96:99], v8 offset:16384
  ds_read_b128 v[100:103], v8 offset:20480
  s_add_u32 m0, s65, 14336
  s_nop 0
  buffer_load_dwordx4 v17, s[56:59], s63 offen  lds
  s_add_u32 s63, s63, 88064
  s_cmp_ge_u32 s63, 1409024
  s_cselect_b32 s3, 1409024, 0
  s_sub_u32 s63, s63, s3
  v_mfma_f32_32x32x16_bf16 v[176:191], v[32:35], v[92:95], v[176:191]
  ds_read_b64_tr_b16 v[44:45], v4 offset:30720
  ds_read_b64_tr_b16 v[46:47], v4 offset:31488
  v_mfma_f32_32x32x16_bf16 v[192:207], v[36:39], v[88:91], v[192:207]
  ds_read_b64_tr_b16 v[48:49], v5 offset:30720
  ds_read_b64_tr_b16 v[50:51], v5 offset:31488
  v_mfma_f32_32x32x16_bf16 v[208:223], v[36:39], v[92:95], v[208:223]
  ds_read_b64_tr_b16 v[52:53], v6 offset:30720
  ds_read_b64_tr_b16 v[54:55], v6 offset:31488
  s_cmp_eq_u32 s12, 0
  s_cbranch_scc0 L_ts2_0
  global_load_dword v159, v158, s[36:37]
L_ts2_0:
  v_mfma_f32_32x32x16_bf16 v[224:239], v[40:43], v[88:91], v[224:239]
  ds_read_b128 v[104:107], v9 offset:16384
  ds_read_b128 v[108:111], v9 offset:20480
  v_mfma_f32_32x32x16_bf16 v[240:255], v[40:43], v[92:95], v[240:255]
  ds_read_b128 v[112:115], v10 offset:16384
  ds_read_b128 v[116:119], v10 offset:20480
  s_cmp_eq_u32 s10, 0
  s_cbranch_scc0 L_cs4_0
  v_mfma_f32_16x16x32_bf16 v[128:131], v[120:123], v[32:35], v[128:131]
L_cs4_0:
  s_cmp_eq_u32 s10, 1
  s_cbranch_scc0 L_cs4_1
  v_mfma_f32_16x16x32_bf16 v[128:131], v[120:123], v[36:39], v[128:131]
L_cs4_1:
  s_cmp_eq_u32 s10, 2
  s_cbranch_scc0 L_cs4_2
  v_mfma_f32_16x16x32_bf16 v[128:131], v[120:123], v[40:43], v[128:131]
L_cs4_2:
  s_waitcnt lgkmcnt(0)
  v_mfma_f32_32x32x16_bf16 v[160:175], v[44:47], v[96:99], v[160:175]
  s_waitcnt vmcnt(10)
  s_barrier
  v_readfirstlane_b32 s49, v25
  s_nop 0
  s_mul_i32 s49, s49, 0x9E3779B1
  s_add_u32 s49, s49, 0x7F4A7C15
  s_or_b32 s49, s49, 1
  ds_read_b64_tr_b16 v[32:33], v4 offset:36864
  ds_read_b64_tr_b16 v[34:35], v4 offset:37632
  v_mfma_f32_32x32x16_bf16 v[176:191], v[44:47], v[100:103], v[176:191]
  ds_read_b64_tr_b16 v[36:37], v5 offset:36864
  ds_read_b64_tr_b16 v[38:39], v5 offset:37632
  s_add_u32 m0, s65, 24576
  s_nop 0
  buffer_load_dwordx4 v15, s[56:59], s63 offen  lds
  v_mfma_f32_32x32x16_bf16 v[192:207], v[48:51], v[96:99], v[192:207]
  ds_read_b64_tr_b16 v[40:41], v6 offset:36864
  ds_read_b64_tr_b16 v[42:43], v6 offset:37632
  s_add_u32 m0, s65, 25600
  s_nop 0
  buffer_load_dwordx4 v16, s[56:59], s63 offen  lds
  v_mfma_f32_32x32x16_bf16 v[208:223], v[48:51], v[100:103], v[208:223]
  s_add_u32 m0, s65, 26624
  s_nop 0
  buffer_load_dwordx4 v17, s[56:59], s63 offen  lds
  s_add_u32 s63, s63, 88064
  s_cmp_ge_u32 s63, 1409024
  s_cselect_b32 s3, 1409024, 0
  s_sub_u32 s63, s63, s3
  v_mfma_f32_32x32x16_bf16 v[224:239], v[52:55], v[96:99], v[224:239]
  s_add_u32 m0, s64, 16384
  s_nop 0
  buffer_load_dwordx4 v11, s[52:55], s62 offen  lds
  v_mfma_f32_32x32x16_bf16 v[240:255], v[52:55], v[100:103], v[240:255]
  s_add_u32 m0, s64, 17408
  s_nop 0
  buffer_load_dwordx4 v12, s[52:55], s62 offen  lds
  s_cmp_eq_u32 s10, 0
  s_cbranch_scc0 L_cs5_0
  v_mfma_f32_16x16x32_bf16 v[128:131], v[120:123], v[44:47], v[128:131]
L_cs5_0:
  s_cmp_eq_u32 s10, 1
  s_cbranch_scc0 L_cs5_1
  v_mfma_f32_16x16x32_bf16 v[128:131], v[120:123], v[48:51], v[128:131]
L_cs5_1:
  s_cmp_eq_u32 s10, 2
  s_cbranch_scc0 L_cs5_2
  v_mfma_f32_16x16x32_bf16 v[128:131], v[120:123], v[52:55], v[128:131]
L_cs5_2:
  s_waitcnt lgkmcnt(0)
  v_mfma_f32_32x32x16_bf16 v[160:175], v[32:35], v[104:107], v[160:175]
  ds_read_b64_tr_b16 v[44:45], v4 offset:43008
  ds_read_b64_tr_b16 v[46:47], v4 offset:43776
  s_add_u32 m0, s64, 18432
  s_nop 0
  buffer_load_dwordx4 v13, s[52:55], s62 offen  lds
  v_mfma_f32_32x32x16_bf16 v[176:191], v[32:35], v[108:111], v[176:191]
  ds_read_b64_tr_b16 v[48:49], v5 offset:43008
  ds_read_b64_tr_b16 v[50:51], v5 offset:43776
  s_add_u32 m0, s64, 19456
  s_nop 0
  buffer_load_dwordx4 v14, s[52:55], s62 offen  lds
  s_add_u32 s62, s62, 128
  s_and_b32 s62, s62, 1023
  v_mfma_f32_32x32x16_bf16 v[192:207], v[36:39], v[104:107], v[192:207]
  ds_read_b64_tr_b16 v[52:53], v6 offset:43008
  ds_read_b64_tr_b16 v[54:55], v6 offset:43776
  v_mfma_f32_32x32x16_bf16 v[208:223], v[36:39], v[108:111], v[208:223]
  s_cmp_eq_u32 s12, 1
  s_cbranch_scc0 L_ts3_0
  global_load_dword v159, v158, s[36:37]
L_ts3_0:
  v_mfma_f32_32x32x16_bf16 v[224:239], v[40:43], v[104:107], v[224:239]
  s_lshl_b32 s3, s47, 4
  s_add_u32 s3, s3, s48
  s_lshl_b32 s3, s3, 4
  s_lshl_b32 s4, s45, 2
  s_add_u32 s3, s3, s4
  s_add_u32 s3, s3, 0x60000
  v_mov_b32 v30, s3
  v_mov_b32 v31, s49
  s_mov_b64 exec, 1
  global_store_dword v30, v31, s[42:43] sc1
  s_mov_b64 exec, -1
  v_mfma_f32_32x32x16_bf16 v[240:255], v[40:43], v[108:111], v[240:255]
  s_cmp_eq_u32 s10, 0
  s_cbranch_scc0 L_cs6_0
  v_mfma_f32_16x16x32_bf16 v[128:131], v[120:123], v[32:35], v[128:131]
L_cs6_0:
  s_cmp_eq_u32 s10, 1
  s_cbranch_scc0 L_cs6_1
  v_mfma_f32_16x16x32_bf16 v[128:131], v[120:123], v[36:39], v[128:131]
L_cs6_1:
  s_cmp_eq_u32 s10, 2
  s_cbranch_scc0 L_cs6_2
  v_mfma_f32_16x16x32_bf16 v[128:131], v[120:123], v[40:43], v[128:131]
L_cs6_2:
  s_waitcnt lgkmcnt(0)
  v_mfma_f32_32x32x16_bf16 v[160:175], v[44:47], v[112:115], v[160:175]
  s_waitcnt vmcnt(11)
  s_barrier
  ds_read_b64_tr_b16 v[32:33], v4 offset:0
  ds_read_b64_tr_b16 v[34:35], v4 offset:768
  v_mfma_f32_32x32x16_bf16 v[176:191], v[44:47], v[116:119], v[176:191]
  ds_read_b64_tr_b16 v[36:37], v5 offset:0
  ds_read_b64_tr_b16 v[38:39], v5 offset:768
  s_add_u32 m0, s65, 36864
  s_nop 0
  buffer_load_dwordx4 v15, s[56:59], s63 offen  lds
  v_mfma_f32_32x32x16_bf16 v[192:207], v[48:51], v[112:115], v[192:207]
  ds_read_b64_tr_b16 v[40:41], v6 offset:0
  ds_read_b64_tr_b16 v[42:43], v6 offset:768
  v_mfma_f32_32x32x16_bf16 v[208:223], v[48:51], v[116:119], v[208:223]
  ds_read_b128 v[56:59], v7 offset:0
  ds_read_b128 v[60:63], v7 offset:4096
  s_add_u32 m0, s65, 37888
  s_nop 0
  buffer_load_dwordx4 v16, s[56:59], s63 offen  lds
  v_mfma_f32_32x32x16_bf16 v[224:239], v[52:55], v[112:115], v[224:239]
  v_mfma_f32_32x32x16_bf16 v[240:255], v[52:55], v[116:119], v[240:255]
  s_cmp_eq_u32 s10, 0
  s_cbranch_scc0 L_cs7_0
  v_mfma_f32_16x16x32_bf16 v[128:131], v[120:123], v[44:47], v[128:131]
L_cs7_0:
  s_cmp_eq_u32 s10, 1
  s_cbranch_scc0 L_cs7_1
  v_mfma_f32_16x16x32_bf16 v[128:131], v[120:123], v[48:51], v[128:131]
L_cs7_1:
  s_cmp_eq_u32 s10, 2
  s_cbranch_scc0 L_cs7_2
  v_mfma_f32_16x16x32_bf16 v[128:131], v[120:123], v[52:55], v[128:131]
L_cs7_2:
  s_waitcnt lgkmcnt(0)
  v_mfma_f32_32x32x16_bf16 v[160:175], v[32:35], v[56:59], v[160:175]
  ds_read_b128 v[64:67], v8 offset:0
  ds_read_b128 v[68:71], v8 offset:4096
  s_add_u32 m0, s65, 38912
  s_nop 0
  buffer_load_dwordx4 v17, s[56:59], s63 offen  lds
  s_add_u32 s63, s63, 88064
  s_cmp_ge_u32 s63, 1409024
  s_cselect_b32 s3, 1409024, 0
  s_sub_u32 s63, s63, s3
  v_mfma_f32_32x32x16_bf16 v[176:191], v[32:35], v[60:63], v[176:191]
  ds_read_b64_tr_b16 v[44:45], v4 offset:6144
  ds_read_b64_tr_b16 v[46:47], v4 offset:6912
  v_mfma_f32_32x32x16_bf16 v[192:207], v[36:39], v[56:59], v[192:207]
  ds_read_b64_tr_b16 v[48:49], v5 offset:6144
  ds_read_b64_tr_b16 v[50:51], v5 offset:6912
  v_mfma_f32_32x32x16_bf16 v[208:223], v[36:39], v[60:63], v[208:223]
  ds_read_b64_tr_b16 v[52:53], v6 offset:6144
  ds_read_b64_tr_b16 v[54:55], v6 offset:6912
  s_cmp_eq_u32 s12, 2
  s_cbranch_scc0 L_ts4_0
  global_load_dword v159, v158, s[36:37]
L_ts4_0:
  v_mfma_f32_32x32x16_bf16 v[224:239], v[40:43], v[56:59], v[224:239]
  ds_read_b128 v[72:75], v9 offset:0
  ds_read_b128 v[76:79], v9 offset:4096
  v_mfma_f32_32x32x16_bf16 v[240:255], v[40:43], v[60:63], v[240:255]
  ds_read_b128 v[80:83], v10 offset:0
  ds_read_b128 v[84:87], v10 offset:4096
  s_cmp_ge_u32 s10, 3
  s_cbranch_scc1 L_cs8
  s_mov_b64 vcc, 0xffff
  s_add_u32 s3, s11, s10
  s_lshl_b32 s3, s3, 10
  s_lshr_b32 s4, s47, 2
  s_lshl_b32 s4, s4, 3
  s_add_u32 s3, s3, s4
  s_add_u32 s3, s3, 0x10000
  v_and_b32 v26, 31, v1
  v_lshl_add_u32 v26, v26, 5, s3
  v_cndmask_b32 v28, v129, v128, vcc
  v_xor_b32 v29, s49, v28
  s_mov_b32 exec_hi, 0
  global_store_dwordx2 v26, v[28:29], s[42:43] sc1
  s_mov_b64 exec, -1
L_cs8:
  s_waitcnt lgkmcnt(0)
  v_mfma_f32_32x32x16_bf16 v[160:175], v[44:47], v[64:67], v[160:175]
  s_waitcnt vmcnt(11)
  s_barrier
  ds_read_b64_tr_b16 v[32:33], v4 offset:12288
  ds_read_b64_tr_b16 v[34:35], v4 offset:13056
  v_mfma_f32_32x32x16_bf16 v[176:191], v[44:47], v[68:71], v[176:191]
  ds_read_b64_tr_b16 v[36:37], v5 offset:12288
  ds_read_b64_tr_b16 v[38:39], v5 offset:13056
  s_add_u32 m0, s65, 0
  s_nop 0
  buffer_load_dwordx4 v15, s[56:59], s63 offen  lds
  v_mfma_f32_32x32x16_bf16 v[192:207], v[48:51], v[64:67], v[192:207]
  ds_read_b64_tr_b16 v[40:41], v6 offset:12288
  ds_read_b64_tr_b16 v[42:43], v6 offset:13056
  s_add_u32 m0, s65, 1024
  s_nop 0
  buffer_load_dwordx4 v16, s[56:59], s63 offen  lds
  v_mfma_f32_32x32x16_bf16 v[208:223], v[48:51], v[68:71], v[208:223]
  s_add_u32 m0, s65, 2048
  s_nop 0
  buffer_load_dwordx4 v17, s[56:59], s63 offen  lds
  s_add_u32 s63, s63, 88064
  s_cmp_ge_u32 s63, 1409024
  s_cselect_b32 s3, 1409024, 0
  s_sub_u32 s63, s63, s3
  v_mfma_f32_32x32x16_bf16 v[224:239], v[52:55], v[64:67], v[224:239]
  s_add_u32 m0, s64, 0
  s_nop 0
  buffer_load_dwordx4 v11, s[52:55], s62 offen  lds
  v_mfma_f32_32x32x16_bf16 v[240:255], v[52:55], v[68:71], v[240:255]
  s_waitcnt lgkmcnt(0)
  v_mfma_f32_32x32x16_bf16 v[160:175], v[32:35], v[72:75], v[160:175]
  ds_read_b64_tr_b16 v[44:45], v4 offset:18432
  ds_read_b64_tr_b16 v[46:47], v4 offset:19200
  s_add_u32 m0, s64, 1024
  s_nop 0
  buffer_load_dwordx4 v12, s[52:55], s62 offen  lds
  v_mfma_f32_32x32x16_bf16 v[176:191], v[32:35], v[76:79], v[176:191]
  ds_read_b64_tr_b16 v[48:49], v5 offset:18432
  ds_read_b64_tr_b16 v[50:51], v5 offset:19200
  s_add_u32 m0, s64, 2048
  s_nop 0
  buffer_load_dwordx4 v13, s[52:55], s62 offen  lds
  v_mfma_f32_32x32x16_bf16 v[192:207], v[36:39], v[72:75], v[192:207]
  ds_read_b64_tr_b16 v[52:53], v6 offset:18432
  ds_read_b64_tr_b16 v[54:55], v6 offset:19200
  v_mfma_f32_32x32x16_bf16 v[208:223], v[36:39], v[76:79], v[208:223]
  s_add_u32 m0, s64, 3072
  s_nop 0
  buffer_load_dwordx4 v14, s[52:55], s62 offen  lds
  s_add_u32 s62, s62, 128
  s_and_b32 s62, s62, 1023
  v_mfma_f32_32x32x16_bf16 v[224:239], v[40:43], v[72:75], v[224:239]
  s_cmp_eq_u32 s12, 3
  s_cbranch_scc0 L_ts5_0
  global_load_dword v159, v158, s[36:37]
L_ts5_0:
  v_mfma_f32_32x32x16_bf16 v[240:255], v[40:43], v[76:79], v[240:255]
  s_waitcnt lgkmcnt(0)
  v_mfma_f32_32x32x16_bf16 v[160:175], v[44:47], v[80:83], v[160:175]
  s_waitcnt vmcnt(11)
  s_barrier
  ds_read_b64_tr_b16 v[32:33], v4 offset:24576
  ds_read_b64_tr_b16 v[34:35], v4 offset:25344
  v_mfma_f32_32x32x16_bf16 v[176:191], v[44:47], v[84:87], v[176:191]
  ds_read_b64_tr_b16 v[36:37], v5 offset:24576
  ds_read_b64_tr_b16 v[38:39], v5 offset:25344
  s_add_u32 m0, s65, 12288
  s_nop 0
  buffer_load_dwordx4 v15, s[56:59], s63 offen  lds
  v_mfma_f32_32x32x16_bf16 v[192:207], v[48:51], v[80:83], v[192:207]
  ds_read_b64_tr_b16 v[40:41], v6 offset:24576
  ds_read_b64_tr_b16 v[42:43], v6 offset:25344
  v_mfma_f32_32x32x16_bf16 v[208:223], v[48:51], v[84:87], v[208:223]
  ds_read_b128 v[88:91], v7 offset:16384
  ds_read_b128 v[92:95], v7 offset:20480
  s_add_u32 m0, s65, 13312
  s_nop 0
  buffer_load_dwordx4 v16, s[56:59], s63 offen  lds
  v_mfma_f32_32x32x16_bf16 v[224:239], v[52:55], v[80:83], v[224:239]
  v_mfma_f32_32x32x16_bf16 v[240:255], v[52:55], v[84:87], v[240:255]
  s_waitcnt lgkmcnt(0)
  v_mfma_f32_32x32x16_bf16 v[160:175], v[32:35], v[88:91], v[160:175]
  ds_read_b128 v[96:99], v8 offset:16384
  ds_read_b128 v[100:103], v8 offset:20480
  s_add_u32 m0, s65, 14336
  s_nop 0
  buffer_load_dwordx4 v17, s[56:59], s63 offen  lds
  s_add_u32 s63, s63, 88064
  s_cmp_ge_u32 s63, 1409024
  s_cselect_b32 s3, 1409024, 0
  s_sub_u32 s63, s63, s3
  v_mfma_f32_32x32x16_bf16 v[176:191], v[32:35], v[92:95], v[176:191]
  ds_read_b64_tr_b16 v[44:45], v4 offset:30720
  ds_read_b64_tr_b16 v[46:47], v4 offset:31488
  v_mfma_f32_32x32x16_bf16 v[192:207], v[36:39], v[88:91], v[192:207]
  ds_read_b64_tr_b16 v[48:49], v5 offset:30720
  ds_read_b64_tr_b16 v[50:51], v5 offset:31488
  v_mfma_f32_32x32x16_bf16 v[208:223], v[36:39], v[92:95], v[208:223]
  ds_read_b64_tr_b16 v[52:53], v6 offset:30720
  ds_read_b64_tr_b16 v[54:55], v6 offset:31488
  s_cmp_eq_u32 s12, 4
  s_cbranch_scc0 L_ts6_0
  global_load_dword v159, v158, s[36:37]
L_ts6_0:
  v_mfma_f32_32x32x16_bf16 v[224:239], v[40:43], v[88:91], v[224:239]
  ds_read_b128 v[104:107], v9 offset:16384
  ds_read_b128 v[108:111], v9 offset:20480
  v_mfma_f32_32x32x16_bf16 v[240:255], v[40:43], v[92:95], v[240:255]
  ds_read_b128 v[112:115], v10 offset:16384
  ds_read_b128 v[116:119], v10 offset:20480
  s_waitcnt lgkmcnt(0)
  v_mfma_f32_32x32x16_bf16 v[160:175], v[44:47], v[96:99], v[160:175]
  s_waitcnt vmcnt(10)
  s_barrier
  ds_read_b64_tr_b16 v[32:33], v4 offset:36864
  ds_read_b64_tr_b16 v[34:35], v4 offset:37632
  v_mfma_f32_32x32x16_bf16 v[176:191], v[44:47], v[100:103], v[176:191]
  ds_read_b64_tr_b16 v[36:37], v5 offset:36864
  ds_read_b64_tr_b16 v[38:39], v5 offset:37632
  s_add_u32 m0, s65, 24576
  s_nop 0
  buffer_load_dwordx4 v15, s[56:59], s63 offen  lds
  v_mfma_f32_32x32x16_bf16 v[192:207], v[48:51], v[96:99], v[192:207]
  ds_read_b64_tr_b16 v[40:41], v6 offset:36864
  ds_read_b64_tr_b16 v[42:43], v6 offset:37632
  s_add_u32 m0, s65, 25600
  s_nop 0
  buffer_load_dwordx4 v16, s[56:59], s63 offen  lds
  v_mfma_f32_32x32x16_bf16 v[208:223], v[48:51], v[100:103], v[208:223]
  s_add_u32 m0, s65, 26624
  s_nop 0
  buffer_load_dwordx4 v17, s[56:59], s63 offen  lds
  s_add_u32 s63, s63, 88064
  s_cmp_ge_u32 s63, 1409024
  s_cselect_b32 s3, 1409024, 0
  s_sub_u32 s63, s63, s3
  v_mfma_f32_32x32x16_bf16 v[224:239], v[52:55], v[96:99], v[224:239]
  s_add_u32 m0, s64, 16384
  s_nop 0
  buffer_load_dwordx4 v11, s[52:55], s62 offen  lds
  v_mfma_f32_32x32x16_bf16 v[240:255], v[52:55], v[100:103], v[240:255]
  s_waitcnt lgkmcnt(0)
  v_mfma_f32_32x32x16_bf16 v[160:175], v[32:35], v[104:107], v[160:175]
  ds_read_b64_tr_b16 v[44:45], v4 offset:43008
  ds_read_b64_tr_b16 v[46:47], v4 offset:43776
  s_add_u32 m0, s64, 17408
  s_nop 0
  buffer_load_dwordx4 v12, s[52:55], s62 offen  lds
  v_mfma_f32_32x32x16_bf16 v[176:191], v[32:35], v[108:111], v[176:191]
  ds_read_b64_tr_b16 v[48:49], v5 offset:43008
  ds_read_b64_tr_b16 v[50:51], v5 offset:43776
  s_add_u32 m0, s64, 18432
  s_nop 0
  buffer_load_dwordx4 v13, s[52:55], s62 offen  lds
  v_mfma_f32_32x32x16_bf16 v[192:207], v[36:39], v[104:107], v[192:207]
  ds_read_b64_tr_b16 v[52:53], v6 offset:43008
  ds_read_b64_tr_b16 v[54:55], v6 offset:43776
  v_mfma_f32_32x32x16_bf16 v[208:223], v[36:39], v[108:111], v[208:223]
  s_add_u32 m0, s64, 19456
  s_nop 0
  buffer_load_dwordx4 v14, s[52:55], s62 offen  lds
  s_add_u32 s62, s62, 128
  s_and_b32 s62, s62, 1023
  v_mfma_f32_32x32x16_bf16 v[224:239], v[40:43], v[104:107], v[224:239]
  s_cmp_eq_u32 s12, 5
  s_cbranch_scc0 L_ts7_0
  global_load_dword v159, v158, s[36:37]
L_ts7_0:
  v_mfma_f32_32x32x16_bf16 v[240:255], v[40:43], v[108:111], v[240:255]
  s_waitcnt lgkmcnt(0)
  v_mfma_f32_32x32x16_bf16 v[160:175], v[44:47], v[112:115], v[160:175]
  s_waitcnt vmcnt(10)
  s_barrier
  ds_read_b64_tr_b16 v[32:33], v4 offset:0
  ds_read_b64_tr_b16 v[34:35], v4 offset:768
  v_mfma_f32_32x32x16_bf16 v[176:191], v[44:47], v[116:119], v[176:191]
  ds_read_b64_tr_b16 v[36:37], v5 offset:0
  ds_read_b64_tr_b16 v[38:39], v5 offset:768
  s_add_u32 m0, s65, 36864
  s_nop 0
  buffer_load_dwordx4 v15, s[56:59], s63 offen  lds
  v_mfma_f32_32x32x16_bf16 v[192:207], v[48:51], v[112:115], v[192:207]
  ds_read_b64_tr_b16 v[40:41], v6 offset:0
  ds_read_b64_tr_b16 v[42:43], v6 offset:768
  v_mfma_f32_32x32x16_bf16 v[208:223], v[48:51], v[116:119], v[208:223]
  ds_read_b128 v[56:59], v7 offset:0
  ds_read_b128 v[60:63], v7 offset:4096
  s_add_u32 m0, s65, 37888
  s_nop 0
  buffer_load_dwordx4 v16, s[56:59], s63 offen  lds
  v_mfma_f32_32x32x16_bf16 v[224:239], v[52:55], v[112:115], v[224:239]
  v_mfma_f32_32x32x16_bf16 v[240:255], v[52:55], v[116:119], v[240:255]
  s_waitcnt lgkmcnt(0)
  v_mfma_f32_32x32x16_bf16 v[160:175], v[32:35], v[56:59], v[160:175]
  ds_read_b128 v[64:67], v8 offset:0
  ds_read_b128 v[68:71], v8 offset:4096
  s_add_u32 m0, s65, 38912
  s_nop 0
  buffer_load_dwordx4 v17, s[56:59], s63 offen  lds
  s_add_u32 s63, s63, 88064
  s_cmp_ge_u32 s63, 1409024
  s_cselect_b32 s3, 1409024, 0
  s_sub_u32 s63, s63, s3
  v_mfma_f32_32x32x16_bf16 v[176:191], v[32:35], v[60:63], v[176:191]
  ds_read_b64_tr_b16 v[44:45], v4 offset:6144
  ds_read_b64_tr_b16 v[46:47], v4 offset:6912
  v_mfma_f32_32x32x16_bf16 v[192:207], v[36:39], v[56:59], v[192:207]
  ds_read_b64_tr_b16 v[48:49], v5 offset:6144
  ds_read_b64_tr_b16 v[50:51], v5 offset:6912
  v_mfma_f32_32x32x16_bf16 v[208:223], v[36:39], v[60:63], v[208:223]
  ds_read_b64_tr_b16 v[52:53], v6 offset:6144
  ds_read_b64_tr_b16 v[54:55], v6 offset:6912
  s_cmp_eq_u32 s12, 0
  s_cbranch_scc0 L_ts8_1
  v_add_u32 v27, 8192, v158
  s_mov_b64 exec, 0x3fffff
  global_load_dword v159, v27, s[36:37]
  s_mov_b64 exec, -1
L_ts8_1:
  v_mfma_f32_32x32x16_bf16 v[224:239], v[40:43], v[56:59], v[224:239]
  ds_read_b128 v[72:75], v9 offset:0
  ds_read_b128 v[76:79], v9 offset:4096
  v_mfma_f32_32x32x16_bf16 v[240:255], v[40:43], v[60:63], v[240:255]
  ds_read_b128 v[80:83], v10 offset:0
  ds_read_b128 v[84:87], v10 offset:4096
  s_waitcnt lgkmcnt(0)
  v_mfma_f32_32x32x16_bf16 v[160:175], v[44:47], v[64:67], v[160:175]
  s_waitcnt vmcnt(10)
  s_barrier
  ds_read_b64_tr_b16 v[32:33], v4 offset:12288
  ds_read_b64_tr_b16 v[34:35], v4 offset:13056
  v_mfma_f32_32x32x16_bf16 v[176:191], v[44:47], v[68:71], v[176:191]
  ds_read_b64_tr_b16 v[36:37], v5 offset:12288
  ds_read_b64_tr_b16 v[38:39], v5 offset:13056
  s_add_u32 m0, s65, 0
  s_nop 0
  buffer_load_dwordx4 v15, s[56:59], s63 offen  lds
  v_mfma_f32_32x32x16_bf16 v[192:207], v[48:51], v[64:67], v[192:207]
  ds_read_b64_tr_b16 v[40:41], v6 offset:12288
  ds_read_b64_tr_b16 v[42:43], v6 offset:13056
  s_add_u32 m0, s65, 1024
  s_nop 0
  buffer_load_dwordx4 v16, s[56:59], s63 offen  lds
  v_mfma_f32_32x32x16_bf16 v[208:223], v[48:51], v[68:71], v[208:223]
  s_add_u32 m0, s65, 2048
  s_nop 0
  buffer_load_dwordx4 v17, s[56:59], s63 offen  lds
  s_add_u32 s63, s63, 88064
  s_cmp_ge_u32 s63, 1409024
  s_cselect_b32 s3, 1409024, 0
  s_sub_u32 s63, s63, s3
  v_mfma_f32_32x32x16_bf16 v[224:239], v[52:55], v[64:67], v[224:239]
  s_add_u32 m0, s64, 0
  s_nop 0
  buffer_load_dwordx4 v11, s[52:55], s62 offen  lds
  v_mfma_f32_32x32x16_bf16 v[240:255], v[52:55], v[68:71], v[240:255]
  s_waitcnt lgkmcnt(0)
  v_mfma_f32_32x32x16_bf16 v[160:175], v[32:35], v[72:75], v[160:175]
  ds_read_b64_tr_b16 v[44:45], v4 offset:18432
  ds_read_b64_tr_b16 v[46:47], v4 offset:19200
  s_add_u32 m0, s64, 1024
  s_nop 0
  buffer_load_dwordx4 v12, s[52:55], s62 offen  lds
  v_mfma_f32_32x32x16_bf16 v[176:191], v[32:35], v[76:79], v[176:191]
  ds_read_b64_tr_b16 v[48:49], v5 offset:18432
  ds_read_b64_tr_b16 v[50:51], v5 offset:19200
  s_add_u32 m0, s64, 2048
  s_nop 0
  buffer_load_dwordx4 v13, s[52:55], s62 offen  lds
  v_mfma_f32_32x32x16_bf16 v[192:207], v[36:39], v[72:75], v[192:207]
  ds_read_b64_tr_b16 v[52:53], v6 offset:18432
  ds_read_b64_tr_b16 v[54:55], v6 offset:19200
  v_mfma_f32_32x32x16_bf16 v[208:223], v[36:39], v[76:79], v[208:223]
  s_add_u32 m0, s64, 3072
  s_nop 0
  buffer_load_dwordx4 v14, s[52:55], s62 offen  lds
  s_add_u32 s62, s62, 128
  s_and_b32 s62, s62, 1023
  v_mfma_f32_32x32x16_bf16 v[224:239], v[40:43], v[72:75], v[224:239]
  s_cmp_eq_u32 s12, 1
  s_cbranch_scc0 L_ts9_1
  v_add_u32 v27, 8192, v158
  s_mov_b64 exec, 0x3fffff
  global_load_dword v159, v27, s[36:37]
  s_mov_b64 exec, -1
L_ts9_1:
  v_mfma_f32_32x32x16_bf16 v[240:255], v[40:43], v[76:79], v[240:255]
  s_waitcnt lgkmcnt(0)
  v_mfma_f32_32x32x16_bf16 v[160:175], v[44:47], v[80:83], v[160:175]
  s_waitcnt vmcnt(10)
  s_barrier
  ds_read_b64_tr_b16 v[32:33], v4 offset:24576
  ds_read_b64_tr_b16 v[34:35], v4 offset:25344
  v_mfma_f32_32x32x16_bf16 v[176:191], v[44:47], v[84:87], v[176:191]
  ds_read_b64_tr_b16 v[36:37], v5 offset:24576
  ds_read_b64_tr_b16 v[38:39], v5 offset:25344
  s_add_u32 m0, s65, 12288
  s_nop 0
  buffer_load_dwordx4 v15, s[56:59], s63 offen  lds
  v_mfma_f32_32x32x16_bf16 v[192:207], v[48:51], v[80:83], v[192:207]
  ds_read_b64_tr_b16 v[40:41], v6 offset:24576
  ds_read_b64_tr_b16 v[42:43], v6 offset:25344
  v_mfma_f32_32x32x16_bf16 v[208:223], v[48:51], v[84:87], v[208:223]
  ds_read_b128 v[88:91], v7 offset:16384
  ds_read_b128 v[92:95], v7 offset:20480
  s_add_u32 m0, s65, 13312
  s_nop 0
  buffer_load_dwordx4 v16, s[56:59], s63 offen  lds
  v_mfma_f32_32x32x16_bf16 v[224:239], v[52:55], v[80:83], v[224:239]
  v_mfma_f32_32x32x16_bf16 v[240:255], v[52:55], v[84:87], v[240:255]
  s_waitcnt lgkmcnt(0)
  v_mfma_f32_32x32x16_bf16 v[160:175], v[32:35], v[88:91], v[160:175]
  ds_read_b128 v[96:99], v8 offset:16384
  ds_read_b128 v[100:103], v8 offset:20480
  s_add_u32 m0, s65, 14336
  s_nop 0
  buffer_load_dwordx4 v17, s[56:59], s63 offen  lds
  s_add_u32 s63, s63, 88064
  s_cmp_ge_u32 s63, 1409024
  s_cselect_b32 s3, 1409024, 0
  s_sub_u32 s63, s63, s3
  v_mfma_f32_32x32x16_bf16 v[176:191], v[32:35], v[92:95], v[176:191]
  ds_read_b64_tr_b16 v[44:45], v4 offset:30720
  ds_read_b64_tr_b16 v[46:47], v4 offset:31488
  v_mfma_f32_32x32x16_bf16 v[192:207], v[36:39], v[88:91], v[192:207]
  ds_read_b64_tr_b16 v[48:49], v5 offset:30720
  ds_read_b64_tr_b16 v[50:51], v5 offset:31488
  v_mfma_f32_32x32x16_bf16 v[208:223], v[36:39], v[92:95], v[208:223]
  ds_read_b64_tr_b16 v[52:53], v6 offset:30720
  ds_read_b64_tr_b16 v[54:55], v6 offset:31488
  s_cmp_eq_u32 s12, 2
  s_cbranch_scc0 L_ts10_1
  v_add_u32 v27, 8192, v158
  s_mov_b64 exec, 0x3fffff
  global_load_dword v159, v27, s[36:37]
  s_mov_b64 exec, -1
L_ts10_1:
  v_mfma_f32_32x32x16_bf16 v[224:239], v[40:43], v[88:91], v[224:239]
  ds_read_b128 v[104:107], v9 offset:16384
  ds_read_b128 v[108:111], v9 offset:20480
  v_mfma_f32_32x32x16_bf16 v[240:255], v[40:43], v[92:95], v[240:255]
  ds_read_b128 v[112:115], v10 offset:16384
  ds_read_b128 v[116:119], v10 offset:20480
  s_waitcnt lgkmcnt(0)
  v_mfma_f32_32x32x16_bf16 v[160:175], v[44:47], v[96:99], v[160:175]
  s_waitcnt vmcnt(10)
  s_barrier
  ds_read_b64_tr_b16 v[32:33], v4 offset:36864
  ds_read_b64_tr_b16 v[34:35], v4 offset:37632
  v_mfma_f32_32x32x16_bf16 v[176:191], v[44:47], v[100:103], v[176:191]
  ds_read_b64_tr_b16 v[36:37], v5 offset:36864
  ds_read_b64_tr_b16 v[38:39], v5 offset:37632
  s_add_u32 m0, s65, 24576
  s_nop 0
  buffer_load_dwordx4 v15, s[56:59], s63 offen  lds
  v_mfma_f32_32x32x16_bf16 v[192:207], v[48:51], v[96:99], v[192:207]
  ds_read_b64_tr_b16 v[40:41], v6 offset:36864
  ds_read_b64_tr_b16 v[42:43], v6 offset:37632
  s_add_u32 m0, s65, 25600
  s_nop 0
  buffer_load_dwordx4 v16, s[56:59], s63 offen  lds
  v_mfma_f32_32x32x16_bf16 v[208:223], v[48:51], v[100:103], v[208:223]
  s_add_u32 m0, s65, 26624
  s_nop 0
  buffer_load_dwordx4 v17, s[56:59], s63 offen  lds
  s_add_u32 s63, s63, 88064
  s_cmp_ge_u32 s63, 1409024
  s_cselect_b32 s3, 1409024, 0
  s_sub_u32 s63, s63, s3
  v_mfma_f32_32x32x16_bf16 v[224:239], v[52:55], v[96:99], v[224:239]
  s_add_u32 m0, s64, 16384
  s_nop 0
  buffer_load_dwordx4 v11, s[52:55], s62 offen  lds
  v_mfma_f32_32x32x16_bf16 v[240:255], v[52:55], v[100:103], v[240:255]
  s_waitcnt lgkmcnt(0)
  v_mfma_f32_32x32x16_bf16 v[160:175], v[32:35], v[104:107], v[160:175]
  ds_read_b64_tr_b16 v[44:45], v4 offset:43008
  ds_read_b64_tr_b16 v[46:47], v4 offset:43776
  s_add_u32 m0, s64, 17408
  s_nop 0
  buffer_load_dwordx4 v12, s[52:55], s62 offen  lds
  v_mfma_f32_32x32x16_bf16 v[176:191], v[32:35], v[108:111], v[176:191]
  ds_read_b64_tr_b16 v[48:49], v5 offset:43008
  ds_read_b64_tr_b16 v[50:51], v5 offset:43776
  s_add_u32 m0, s64, 18432
  s_nop 0
  buffer_load_dwordx4 v13, s[52:55], s62 offen  lds
  v_mfma_f32_32x32x16_bf16 v[192:207], v[36:39], v[104:107], v[192:207]
  ds_read_b64_tr_b16 v[52:53], v6 offset:43008
  ds_read_b64_tr_b16 v[54:55], v6 offset:43776
  v_mfma_f32_32x32x16_bf16 v[208:223], v[36:39], v[108:111], v[208:223]
  s_add_u32 m0, s64, 19456
  s_nop 0
  buffer_load_dwordx4 v14, s[52:55], s62 offen  lds
  s_add_u32 s62, s62, 128
  s_and_b32 s62, s62, 1023
  v_mfma_f32_32x32x16_bf16 v[224:239], v[40:43], v[104:107], v[224:239]
  s_cmp_eq_u32 s12, 3
  s_cbranch_scc0 L_ts11_1
  v_add_u32 v27, 8192, v158
  s_mov_b64 exec, 0x3fffff
  global_load_dword v159, v27, s[36:37]
  s_mov_b64 exec, -1
L_ts11_1:
  v_mfma_f32_32x32x16_bf16 v[240:255], v[40:43], v[108:111], v[240:255]
  s_waitcnt lgkmcnt(0)
  v_mfma_f32_32x32x16_bf16 v[160:175], v[44:47], v[112:115], v[160:175]
  s_waitcnt vmcnt(10)
  s_barrier
  ds_read_b64_tr_b16 v[32:33], v4 offset:0
  ds_read_b64_tr_b16 v[34:35], v4 offset:768
  v_mfma_f32_32x32x16_bf16 v[176:191], v[44:47], v[116:119], v[176:191]
  ds_read_b64_tr_b16 v[36:37], v5 offset:0
  ds_read_b64_tr_b16 v[38:39], v5 offset:768
  s_add_u32 m0, s65, 36864
  s_nop 0
  buffer_load_dwordx4 v15, s[56:59], s63 offen  lds
  v_mfma_f32_32x32x16_bf16 v[192:207], v[48:51], v[112:115], v[192:207]
  ds_read_b64_tr_b16 v[40:41], v6 offset:0
  ds_read_b64_tr_b16 v[42:43], v6 offset:768
  s_add_u32 m0, s65, 37888
  s_nop 0
  buffer_load_dwordx4 v16, s[56:59], s63 offen  lds
  v_mfma_f32_32x32x16_bf16 v[208:223], v[48:51], v[116:119], v[208:223]
  ds_read_b128 v[56:59], v7 offset:0
  ds_read_b128 v[60:63], v7 offset:4096
  s_add_u32 m0, s65, 38912
  s_nop 0
  buffer_load_dwordx4 v17, s[56:59], s63 offen  lds
  s_add_u32 s63, s63, 88064
  s_cmp_ge_u32 s63, 1409024
  s_cselect_b32 s3, 1409024, 0
  s_sub_u32 s63, s63, s3
  v_mfma_f32_32x32x16_bf16 v[224:239], v[52:55], v[112:115], v[224:239]
  s_cmp_eq_u32 s12, 4
  s_cbranch_scc0 L_ts12_1
  v_add_u32 v27, 8192, v158
  s_mov_b64 exec, 0x3fffff
  global_load_dword v159, v27, s[36:37]
  s_mov_b64 exec, -1
L_ts12_1:
  v_mfma_f32_32x32x16_bf16 v[240:255], v[52:55], v[116:119], v[240:255]
  global_load_dwordx2 v[18:19], v2, s[42:43] sc1
  s_waitcnt lgkmcnt(0)
  v_mfma_f32_32x32x16_bf16 v[160:175], v[32:35], v[56:59], v[160:175]
  ds_read_b128 v[64:67], v8 offset:0
  ds_read_b128 v[68:71], v8 offset:4096
  global_load_dwordx2 v[20:21], v2, s[42:43] offset:256 sc1
  v_mfma_f32_32x32x16_bf16 v[176:191], v[32:35], v[60:63], v[176:191]
  ds_read_b64_tr_b16 v[44:45], v4 offset:6144
  ds_read_b64_tr_b16 v[46:47], v4 offset:6912
  global_load_dwordx4 v[128:131], v3, s[42:43] offset:0 sc1
  v_mfma_f32_32x32x16_bf16 v[192:207], v[36:39], v[56:59], v[192:207]
  ds_read_b64_tr_b16 v[48:49], v5 offset:6144
  ds_read_b64_tr_b16 v[50:51], v5 offset:6912
  v_mfma_f32_32x32x16_bf16 v[208:223], v[36:39], v[60:63], v[208:223]
  ds_read_b64_tr_b16 v[52:53], v6 offset:6144
  ds_read_b64_tr_b16 v[54:55], v6 offset:6912
  global_load_dwordx4 v[132:135], v3, s[42:43] offset:1024 sc1
  v_mfma_f32_32x32x16_bf16 v[224:239], v[40:43], v[56:59], v[224:239]
  ds_read_b128 v[72:75], v9 offset:0
  ds_read_b128 v[76:79], v9 offset:4096
  global_load_dwordx4 v[136:139], v3, s[42:43] offset:2048 sc1
  v_mfma_f32_32x32x16_bf16 v[240:255], v[40:43], v[60:63], v[240:255]
  ds_read_b128 v[80:83], v10 offset:0
  ds_read_b128 v[84:87], v10 offset:4096
  s_waitcnt lgkmcnt(0)
  v_mfma_f32_32x32x16_bf16 v[160:175], v[44:47], v[64:67], v[160:175]
  s_waitcnt vmcnt(15)
  s_barrier
  ds_read_b64_tr_b16 v[32:33], v4 offset:12288
  ds_read_b64_tr_b16 v[34:35], v4 offset:13056
  v_mfma_f32_32x32x16_bf16 v[176:191], v[44:47], v[68:71], v[176:191]
  ds_read_b64_tr_b16 v[36:37], v5 offset:12288
  ds_read_b64_tr_b16 v[38:39], v5 offset:13056
  s_cmp_eq_u32 s12, 5
  s_cbranch_scc0 L_ts13_1
  v_add_u32 v27, 8192, v158
  s_mov_b64 exec, 0x3fffff
  global_load_dword v159, v27, s[36:37]
  s_mov_b64 exec, -1
L_ts13_1:
  v_mfma_f32_32x32x16_bf16 v[192:207], v[48:51], v[64:67], v[192:207]
  ds_read_b64_tr_b16 v[40:41], v6 offset:12288
  ds_read_b64_tr_b16 v[42:43], v6 offset:13056
  s_lshl_b32 s3, s51, 7
  s_add_u32 s52, s36, s3
  s_addc_u32 s53, s37, 0
  s_and_b32 s53, s53, 0xffff
  s_sub_u32 s54, 1409024, s3
  s_mov_b32 s55, 0x20000
  s_mul_i32 s3, s45, 22
  s_cmp_ge_u32 s45, 2
  s_subb_u32 s3, s3, 0
  s_cmp_ge_u32 s45, 3
  s_subb_u32 s3, s3, 0
  s_lshl_b32 s62, s3, 14
  s_lshl_b32 s63, s3, 10
  s_lshl_b32 s64, s45, 11
  v_lshrrev_b32 v26, 3, v1
  v_and_b32 v27, 7, v1
  v_bfe_u32 v28, v1, 4, 1
  v_lshlrev_b32 v28, 2, v28
  v_xor_b32 v27, v27, v28
  v_lshlrev_b32 v27, 4, v27
  v_lshl_add_u32 v11, v26, 10, v27
  v_add_u32 v12, 8192, v11
  v_mfma_f32_32x32x16_bf16 v[208:223], v[48:51], v[68:71], v[208:223]
  s_add_u32 m0, s64, 0
  s_nop 0
  buffer_load_dwordx4 v11, s[52:55], s62 offen lds
  v_mfma_f32_32x32x16_bf16 v[224:239], v[52:55], v[64:67], v[224:239]
  s_add_u32 m0, s64, 1024
  s_nop 0
  buffer_load_dwordx4 v12, s[52:55], s62 offen lds
  s_add_u32 s62, s62, 16384
  v_mfma_f32_32x32x16_bf16 v[240:255], v[52:55], v[68:71], v[240:255]
  s_waitcnt lgkmcnt(0)
  v_mfma_f32_32x32x16_bf16 v[160:175], v[32:35], v[72:75], v[160:175]
  ds_read_b64_tr_b16 v[44:45], v4 offset:18432
  ds_read_b64_tr_b16 v[46:47], v4 offset:19200
  s_add_u32 m0, s64, 49152
  s_nop 0
  buffer_load_dwordx4 v11, s[52:55], s62 offen lds
  v_mfma_f32_32x32x16_bf16 v[176:191], v[32:35], v[76:79], v[176:191]
  ds_read_b64_tr_b16 v[48:49], v5 offset:18432
  ds_read_b64_tr_b16 v[50:51], v5 offset:19200
  s_add_u32 m0, s64, 50176
  s_nop 0
  buffer_load_dwordx4 v12, s[52:55], s62 offen lds
  s_add_u32 s62, s62, 16384
  v_mfma_f32_32x32x16_bf16 v[192:207], v[36:39], v[72:75], v[192:207]
  ds_read_b64_tr_b16 v[52:53], v6 offset:18432
  ds_read_b64_tr_b16 v[54:55], v6 offset:19200
  v_mfma_f32_32x32x16_bf16 v[208:223], v[36:39], v[76:79], v[208:223]
  s_add_u32 m0, s64, 57344
  s_nop 0
  buffer_load_dwordx4 v11, s[52:55], s62 offen lds
  v_mfma_f32_32x32x16_bf16 v[224:239], v[40:43], v[72:75], v[224:239]
  s_add_u32 m0, s64, 58368
  s_nop 0
  buffer_load_dwordx4 v12, s[52:55], s62 offen lds
  s_add_u32 s62, s62, 16384
  v_mfma_f32_32x32x16_bf16 v[240:255], v[40:43], v[76:79], v[240:255]
  s_waitcnt lgkmcnt(0)
  v_mfma_f32_32x32x16_bf16 v[160:175], v[44:47], v[80:83], v[160:175]
  s_waitcnt vmcnt(14)
  s_barrier
  ds_read_b64_tr_b16 v[32:33], v4 offset:24576
  ds_read_b64_tr_b16 v[34:35], v4 offset:25344
  v_mfma_f32_32x32x16_bf16 v[176:191], v[44:47], v[84:87], v[176:191]
  ds_read_b64_tr_b16 v[36:37], v5 offset:24576
  ds_read_b64_tr_b16 v[38:39], v5 offset:25344
  s_add_u32 m0, s64, 8192
  s_nop 0
  buffer_load_dwordx4 v11, s[52:55], s62 offen lds
  v_mfma_f32_32x32x16_bf16 v[192:207], v[48:51], v[80:83], v[192:207]
  ds_read_b64_tr_b16 v[40:41], v6 offset:24576
  ds_read_b64_tr_b16 v[42:43], v6 offset:25344
  v_mfma_f32_32x32x16_bf16 v[208:223], v[48:51], v[84:87], v[208:223]
  ds_read_b128 v[88:91], v7 offset:16384
  ds_read_b128 v[92:95], v7 offset:20480
  s_add_u32 m0, s64, 9216
  s_nop 0
  buffer_load_dwordx4 v12, s[52:55], s62 offen lds
  s_add_u32 s62, s62, 16384
  v_mfma_f32_32x32x16_bf16 v[224:239], v[52:55], v[80:83], v[224:239]
  v_mfma_f32_32x32x16_bf16 v[240:255], v[52:55], v[84:87], v[240:255]
  s_waitcnt lgkmcnt(0)
  v_mfma_f32_32x32x16_bf16 v[160:175], v[32:35], v[88:91], v[160:175]
  ds_read_b128 v[96:99], v8 offset:16384
  ds_read_b128 v[100:103], v8 offset:20480
  s_add_u32 m0, s64, 16384
  s_nop 0
  buffer_load_dwordx4 v11, s[52:55], s62 offen lds
  v_mfma_f32_32x32x16_bf16 v[176:191], v[32:35], v[92:95], v[176:191]
  ds_read_b64_tr_b16 v[44:45], v4 offset:30720
  ds_read_b64_tr_b16 v[46:47], v4 offset:31488
  v_mfma_f32_32x32x16_bf16 v[192:207], v[36:39], v[88:91], v[192:207]
  ds_read_b64_tr_b16 v[48:49], v5 offset:30720
  ds_read_b64_tr_b16 v[50:51], v5 offset:31488
  v_mfma_f32_32x32x16_bf16 v[208:223], v[36:39], v[92:95], v[208:223]
  ds_read_b64_tr_b16 v[52:53], v6 offset:30720
  ds_read_b64_tr_b16 v[54:55], v6 offset:31488
  s_add_u32 m0, s64, 17408
  s_nop 0
  buffer_load_dwordx4 v12, s[52:55], s62 offen lds
  s_add_u32 s62, s62, 16384
  v_mfma_f32_32x32x16_bf16 v[224:239], v[40:43], v[88:91], v[224:239]
  ds_read_b128 v[104:107], v9 offset:16384
  ds_read_b128 v[108:111], v9 offset:20480
  v_mfma_f32_32x32x16_bf16 v[240:255], v[40:43], v[92:95], v[240:255]
  ds_read_b128 v[112:115], v10 offset:16384
  ds_read_b128 v[116:119], v10 offset:20480
  s_waitcnt lgkmcnt(0)
  v_mfma_f32_32x32x16_bf16 v[160:175], v[44:47], v[96:99], v[160:175]
  s_waitcnt vmcnt(15)
  s_barrier
  ds_read_b64_tr_b16 v[32:33], v4 offset:36864
  ds_read_b64_tr_b16 v[34:35], v4 offset:37632
  v_mfma_f32_32x32x16_bf16 v[176:191], v[44:47], v[100:103], v[176:191]
  ds_read_b64_tr_b16 v[36:37], v5 offset:36864
  ds_read_b64_tr_b16 v[38:39], v5 offset:37632
  s_add_u32 m0, s64, 24576
  s_nop 0
  buffer_load_dwordx4 v11, s[52:55], s62 offen lds
  v_mfma_f32_32x32x16_bf16 v[192:207], v[48:51], v[96:99], v[192:207]
  ds_read_b64_tr_b16 v[40:41], v6 offset:36864
  ds_read_b64_tr_b16 v[42:43], v6 offset:37632
  s_add_u32 m0, s64, 25600
  s_nop 0
  buffer_load_dwordx4 v12, s[52:55], s62 offen lds
  s_add_u32 s62, s62, 16384
  v_mfma_f32_32x32x16_bf16 v[208:223], v[48:51], v[100:103], v[208:223]
  v_mfma_f32_32x32x16_bf16 v[224:239], v[52:55], v[96:99], v[224:239]
  s_add_u32 m0, s64, 65536
  s_nop 0
  buffer_load_dwordx4 v11, s[52:55], s62 offen lds
  v_mfma_f32_32x32x16_bf16 v[240:255], v[52:55], v[100:103], v[240:255]
  s_waitcnt vmcnt(13)
  s_waitcnt lgkmcnt(0)
  v_mfma_f32_32x32x16_bf16 v[160:175], v[32:35], v[104:107], v[160:175]
  ds_read_b64_tr_b16 v[44:45], v4 offset:43008
  ds_read_b64_tr_b16 v[46:47], v4 offset:43776
  s_add_u32 m0, s64, 66560
  s_nop 0
  buffer_load_dwordx4 v12, s[52:55], s62 offen lds
  s_add_u32 s62, s62, 16384
  v_xor_b32 v26, v18, v19
  v_xor_b32 v27, v20, v21
  v_xor_b32 v28, v128, v129
  v_xor_b32 v29, v130, v131
  v_xor_b32 v30, v132, v133
  v_xor_b32 v31, v134, v135
  v_min3_u32 v23, v26, v27, v28
  v_max3_u32 v26, v26, v27, v28
  v_min3_u32 v23, v23, v29, v30
  v_mfma_f32_32x32x16_bf16 v[176:191], v[32:35], v[108:111], v[176:191]
  ds_read_b64_tr_b16 v[48:49], v5 offset:43008
  ds_read_b64_tr_b16 v[50:51], v5 offset:43776
  v_max3_u32 v26, v26, v29, v30
  v_xor_b32 v27, v136, v137
  v_xor_b32 v28, v138, v139
  v_min3_u32 v23, v23, v31, v27
  v_max3_u32 v26, v26, v31, v27
  v_min_u32 v23, v23, v28
  v_max_u32 v26, v26, v28
  v_cmp_ne_u32 vcc, s49, v23
  v_cmp_ne_u32 s[4:5], s49, v26
  v_mfma_f32_32x32x16_bf16 v[192:207], v[36:39], v[104:107], v[192:207]
  ds_read_b64_tr_b16 v[52:53], v6 offset:43008
  ds_read_b64_tr_b16 v[54:55], v6 offset:43776
  s_add_u32 m0, s64, 73728
  s_nop 0
  buffer_load_dwordx4 v11, s[52:55], s62 offen lds
  s_or_b64 vcc, vcc, s[4:5]
  s_cbranch_vccnz L_late_slow
L_late_ok:
  s_mov_b32 s3, 0x01000100
  v_perm_b32 v124, v18, v18, s3
  v_perm_b32 v120, v20, v20, s3
  v_xor_b32 v124, 0x80008000, v124
  v_xor_b32 v120, 0x80008000, v120
  v_add_f32 v136, v136, v138
  v_add_f32 v132, v132, v134
  v_mfma_f32_32x32x16_bf16 v[208:223], v[36:39], v[108:111], v[208:223]
  v_add_f32 v128, v128, v130
  v_cvt_pk_bf16_f32 v137, v136, v136
  v_cvt_pk_bf16_f32 v133, v132, v132
  v_cvt_pk_bf16_f32 v129, v128, v128
  v_lshlrev_b32 v137, 16, v137
  v_lshlrev_b32 v133, 16, v133
  v_lshlrev_b32 v129, 16, v129
  v_sub_f32 v137, v136, v137
  v_sub_f32 v133, v132, v133
  v_mfma_f32_32x32x16_bf16 v[224:239], v[40:43], v[104:107], v[224:239]
  s_add_u32 m0, s64, 74752
  s_nop 0
  buffer_load_dwordx4 v12, s[52:55], s62 offen lds
  s_add_u32 s62, s62, 16384
  v_sub_f32 v129, v128, v129
  v_cvt_pk_bf16_f32 v136, v136, v137
  v_cvt_pk_bf16_f32 v132, v132, v133
  v_cvt_pk_bf16_f32 v128, v128, v129
  v_mov_b32 v137, 0
  v_mov_b32 v138, 0
  v_mov_b32 v139, 0
  v_mov_b32 v133, 0
  v_mov_b32 v134, 0
  v_mfma_f32_32x32x16_bf16 v[240:255], v[40:43], v[108:111], v[240:255]
  v_mov_b32 v135, 0
  v_mov_b32 v129, 0
  v_mov_b32 v130, 0
  v_mov_b32 v131, 0
  s_waitcnt lgkmcnt(0)
  v_mfma_f32_32x32x16_bf16 v[160:175], v[44:47], v[112:115], v[160:175]
  s_barrier
  v_bfe_u32 v26, v1, 2, 2
  v_lshrrev_b32 v27, 5, v1
  v_lshl_add_u32 v27, v27, 2, v26
  v_lshlrev_b32 v27, 7, v27
  v_mfma_f32_32x32x16_bf16 v[176:191], v[44:47], v[116:119], v[176:191]
  s_add_u32 m0, s64, 32768
  s_nop 0
  buffer_load_dwordx4 v11, s[52:55], s62 offen lds
  v_bfe_u32 v28, v1, 4, 1
  v_lshlrev_b32 v28, 5, v28
  v_and_b32 v29, 3, v1
  v_lshlrev_b32 v29, 3, v29
  v_mfma_f32_32x32x16_bf16 v[192:207], v[48:51], v[112:115], v[192:207]
  s_add_u32 m0, s64, 33792
  s_nop 0
  buffer_load_dwordx4 v12, s[52:55], s62 offen lds
  s_add_u32 s62, s62, 16384
  v_add3_u32 v27, v27, v28, v29
  v_add_u32 v27, s64, v27
  v_bfe_u32 v28, v1, 3, 1
  v_lshlrev_b32 v28, 6, v28
  v_mfma_f32_32x32x16_bf16 v[208:223], v[48:51], v[116:119], v[208:223]
  s_add_u32 m0, s64, 40960
  s_nop 0
  buffer_load_dwordx4 v11, s[52:55], s62 offen lds
  v_add_u32 v8, v27, v28
  v_xor_b32 v28, 64, v28
  v_add_u32 v9, v27, v28
  v_add_u32 v4, 0x10000, v8
  v_mfma_f32_32x32x16_bf16 v[224:239], v[52:55], v[112:115], v[224:239]
  s_add_u32 m0, s64, 41984
  s_nop 0
  buffer_load_dwordx4 v12, s[52:55], s62 offen lds
  s_add_u32 s62, s62, 16384
  v_add_u32 v5, 0x10000, v9
  s_add_u32 s68, s42, 0x1000000
  s_addc_u32 s69, s43, 0
  v_mfma_f32_32x32x16_bf16 v[240:255], v[52:55], v[116:119], v[240:255]
  v_mfma_f32_32x32x16_bf16 v[224:239], v[136:139], v[124:127], v[224:239]
  v_mfma_f32_32x32x16_bf16 v[240:255], v[136:139], v[120:123], v[240:255]
  v_mfma_f32_32x32x16_bf16 v[192:207], v[132:135], v[124:127], v[192:207]
  v_mfma_f32_32x32x16_bf16 v[208:223], v[132:135], v[120:123], v[208:223]
  v_mfma_f32_32x32x16_bf16 v[160:175], v[128:131], v[124:127], v[160:175]
  v_mfma_f32_32x32x16_bf16 v[176:191], v[128:131], v[120:123], v[176:191]
  s_add_u32 s5, s11, 2
  s_cmp_ge_u32 s5, 86
  s_cselect_b32 s6, s68, s66
  s_cselect_b32 s7, s69, s67
  v_add_u32 v26, 2048, v24
  s_nop 1
  v_mul_f32 v224, v224, v232
  v_mul_f32 v225, v225, v233
  v_mul_f32 v226, v226, v234
  v_mul_f32 v227, v227, v235
  v_mul_f32 v228, v228, v236
  v_mul_f32 v229, v229, v237
  v_mul_f32 v230, v230, v238
  v_mul_f32 v231, v231, v239
  v_cvt_pk_bf16_f32 v232, v224, v225
  v_cvt_pk_bf16_f32 v233, v226, v227
  v_cvt_pk_bf16_f32 v234, v228, v229
  v_cvt_pk_bf16_f32 v235, v230, v231
  global_store_dwordx4 v26, v[232:235], s[6:7] sc1
  v_add_u32 v27, 90112, v24
  v_mul_f32 v240, v240, v248
  v_mul_f32 v241, v241, v249
  v_mul_f32 v242, v242, v250
  v_mul_f32 v243, v243, v251
  v_mul_f32 v244, v244, v252
  v_mul_f32 v245, v245, v253
  v_mul_f32 v246, v246, v254
  v_mul_f32 v247, v247, v255
  v_cvt_pk_bf16_f32 v248, v240, v241
  v_cvt_pk_bf16_f32 v249, v242, v243
  v_cvt_pk_bf16_f32 v250, v244, v245
  v_cvt_pk_bf16_f32 v251, v246, v247
  global_store_dwordx4 v27, v[248:251], s[6:7] sc1
  s_add_u32 s5, s11, 1
  s_cmp_ge_u32 s5, 86
  s_cselect_b32 s6, s68, s66
  s_cselect_b32 s7, s69, s67
  v_add_u32 v26, 1024, v24
  v_mul_f32 v192, v192, v200
  v_mul_f32 v193, v193, v201
  v_mul_f32 v194, v194, v202
  v_mul_f32 v195, v195, v203
  v_mul_f32 v196, v196, v204
  v_mul_f32 v197, v197, v205
  v_mul_f32 v198, v198, v206
  v_mul_f32 v199, v199, v207
  v_cvt_pk_bf16_f32 v200, v192, v193
  v_cvt_pk_bf16_f32 v201, v194, v195
  v_cvt_pk_bf16_f32 v202, v196, v197
  v_cvt_pk_bf16_f32 v203, v198, v199
  global_store_dwordx4 v26, v[200:203], s[6:7] sc1
  v_add_u32 v27, 89088, v24
  v_mul_f32 v208, v208, v216
  v_mul_f32 v209, v209, v217
  v_mul_f32 v210, v210, v218
  v_mul_f32 v211, v211, v219
  v_mul_f32 v212, v212, v220
  v_mul_f32 v213, v213, v221
  v_mul_f32 v214, v214, v222
  v_mul_f32 v215, v215, v223
  v_cvt_pk_bf16_f32 v216, v208, v209
  v_cvt_pk_bf16_f32 v217, v210, v211
  v_cvt_pk_bf16_f32 v218, v212, v213
  v_cvt_pk_bf16_f32 v219, v214, v215
  global_store_dwordx4 v27, v[216:219], s[6:7] sc1
  s_add_u32 s5, s11, 0
  s_cmp_ge_u32 s5, 86
  s_cselect_b32 s6, s68, s66
  s_cselect_b32 s7, s69, s67
  v_add_u32 v26, 0, v24
  v_mul_f32 v160, v160, v168
  v_mul_f32 v161, v161, v169
  v_mul_f32 v162, v162, v170
  v_mul_f32 v163, v163, v171
  v_mul_f32 v164, v164, v172
  v_mul_f32 v165, v165, v173
  v_mul_f32 v166, v166, v174
  v_mul_f32 v167, v167, v175
  v_cvt_pk_bf16_f32 v168, v160, v161
  v_cvt_pk_bf16_f32 v169, v162, v163
  v_cvt_pk_bf16_f32 v170, v164, v165
  v_cvt_pk_bf16_f32 v171, v166, v167
  global_store_dwordx4 v26, v[168:171], s[6:7] sc1
  v_add_u32 v27, 88064, v24
  v_mul_f32 v176, v176, v184
  v_mul_f32 v177, v177, v185
  v_mul_f32 v178, v178, v186
  v_mul_f32 v179, v179, v187
  v_mul_f32 v180, v180, v188
  v_mul_f32 v181, v181, v189
  v_mul_f32 v182, v182, v190
  v_mul_f32 v183, v183, v191
  v_cvt_pk_bf16_f32 v184, v176, v177
  v_cvt_pk_bf16_f32 v185, v178, v179
  v_cvt_pk_bf16_f32 v186, v180, v181
  v_cvt_pk_bf16_f32 v187, v182, v183
  global_store_dwordx4 v27, v[184:187], s[6:7] sc1
  s_waitcnt vmcnt(24)
  ds_read_b64_tr_b16 v[88:89], v8 offset:0
  ds_read_b64_tr_b16 v[90:91], v8 offset:1024
  ds_read_b64_tr_b16 v[92:93], v9 offset:0
  ds_read_b64_tr_b16 v[94:95], v9 offset:1024
  s_waitcnt vmcnt(22)
  ds_read_b64_tr_b16 v[96:97], v8 offset:49152
  ds_read_b64_tr_b16 v[98:99], v8 offset:50176
  ds_read_b64_tr_b16 v[100:101], v9 offset:49152
  ds_read_b64_tr_b16 v[102:103], v9 offset:50176
  s_waitcnt vmcnt(20)
  ds_read_b64_tr_b16 v[104:105], v8 offset:57344
  ds_read_b64_tr_b16 v[106:107], v8 offset:58368
  ds_read_b64_tr_b16 v[108:109], v9 offset:57344
  ds_read_b64_tr_b16 v[110:111], v9 offset:58368
  s_waitcnt vmcnt(18)
  ds_read_b64_tr_b16 v[112:113], v8 offset:8192
  ds_read_b64_tr_b16 v[114:115], v8 offset:9216
  ds_read_b64_tr_b16 v[116:117], v9 offset:8192
  ds_read_b64_tr_b16 v[118:119], v9 offset:9216
  s_waitcnt vmcnt(16)
  ds_read_b64_tr_b16 v[120:121], v8 offset:16384
  ds_read_b64_tr_b16 v[122:123], v8 offset:17408
  ds_read_b64_tr_b16 v[124:125], v9 offset:16384
  ds_read_b64_tr_b16 v[126:127], v9 offset:17408
  s_waitcnt vmcnt(14)
  ds_read_b64_tr_b16 v[128:129], v8 offset:24576
  ds_read_b64_tr_b16 v[130:131], v8 offset:25600
  ds_read_b64_tr_b16 v[132:133], v9 offset:24576
  ds_read_b64_tr_b16 v[134:135], v9 offset:25600
  s_waitcnt vmcnt(12)
  ds_read_b64_tr_b16 v[32:33], v4 offset:0
  ds_read_b64_tr_b16 v[34:35], v4 offset:1024
  ds_read_b64_tr_b16 v[36:37], v5 offset:0
  ds_read_b64_tr_b16 v[38:39], v5 offset:1024
  s_waitcnt vmcnt(10)
  ds_read_b64_tr_b16 v[40:41], v4 offset:8192
  ds_read_b64_tr_b16 v[42:43], v4 offset:9216
  ds_read_b64_tr_b16 v[44:45], v5 offset:8192
  ds_read_b64_tr_b16 v[46:47], v5 offset:9216
  s_waitcnt vmcnt(8)
  ds_read_b64_tr_b16 v[48:49], v8 offset:32768
  ds_read_b64_tr_b16 v[50:51], v8 offset:33792
  ds_read_b64_tr_b16 v[52:53], v9 offset:32768
  ds_read_b64_tr_b16 v[54:55], v9 offset:33792
  s_waitcnt vmcnt(6)
  ds_read_b64_tr_b16 v[140:141], v8 offset:40960
  ds_read_b64_tr_b16 v[142:143], v8 offset:41984
  ds_read_b64_tr_b16 v[144:145], v9 offset:40960
  ds_read_b64_tr_b16 v[146:147], v9 offset:41984
  s_lshl_b32 s7, s47, 4
  s_add_u32 s7, s7, s48
  s_lshl_b32 s7, s7, 2
  s_add_u32 s7, s7, s45
  s_lshl_b32 s7, s7, 7
  s_mul_i32 s3, s50, 176128
  s_add_u32 s3, s3, 0x500000
  s_add_u32 s56, s42, s3
  s_addc_u32 s57, s43, 0
  s_and_b32 s57, s57, 0xffff
  s_mov_b32 s58, 176128
  s_mov_b32 s59, 0x20000
  v_lshlrev_b32 v6, 4, v1
  v_add_u32 v7, 88064, v6
  s_lshr_b32 s3, s50, 1
  s_lshl_b32 s3, s3, 6
  s_and_b32 s4, s50, 1
  s_lshl_b32 s4, s4, 1
  s_add_u32 s3, s3, s4
  v_lshrrev_b32 v13, 1, v1
  v_lshlrev_b32 v13, 2, v13
  v_and_b32 v14, 1, v1
  v_add3_u32 v13, v13, v14, s3
  v_lshlrev_b32 v13, 7, v13
  v_add_u32 v19, 0x40000, v13
  s_mov_b32 s8, 0xff
  s_cmp_eq_u32 s45, 1
  s_cselect_b32 s8, 0x7f80, s8
  s_cmp_eq_u32 s45, 2
  s_cselect_b32 s8, 0x3fc000, s8
  s_cmp_eq_u32 s45, 3
  s_cselect_b32 s8, 0x1fe00000, s8
  s_mov_b32 s9, 0
  v_and_b32 v13, 31, v1
  v_lshrrev_b32 v14, 5, v1
  s_lshl_b32 s3, s50, 6
  s_and_b32 s4, s45, 1
  s_lshl_b32 s4, s4, 5
  s_add_u32 s3, s3, s4
  s_lshl_b32 s5, s3, 10
  s_lshl_b32 s4, s51, 7
  s_add_u32 s5, s5, s4
  s_lshr_b32 s4, s45, 1
  s_lshl_b32 s4, s4, 6
  s_add_u32 s5, s5, s4
  v_lshlrev_b32 v10, 10, v13
  v_lshl_add_u32 v10, v14, 4, v10
  v_add_u32 v10, s5, v10
  s_lshl_b32 s3, s3, 3
  s_add_u32 s3, s3, 0x8000
  v_lshl_add_u32 v23, v13, 3, s3
  v_lshrrev_b32 v13, 3, v0
  v_and_b32 v14, 7, v0
  s_lshl_b32 s3, s51, 19
  s_lshl_b32 s4, s50, 8
  s_add_u32 s3, s3, s4
  s_add_u32 s3, s3, 0xb00000
  v_lshlrev_b32 v2, 13, v13
  v_lshl_add_u32 v2, v14, 5, v2
  v_add_u32 v2, s3, v2
  v_add_u32 v21, 262144, v2
  v_and_b32 v13, 7, v13
  v_mul_u32_u24 v3, 144, v13
  v_lshl_add_u32 v3, v14, 4, v3
  s_add_u32 s3, s64, 0x10000
  v_add_u32 v3, s3, v3
  v_add_u32 v22, 8192, v3
  s_waitcnt vmcnt(0)
  s_add_u32 s3, s7, 0x40000
  v_mov_b32 v13, s3
  v_mov_b32 v14, s49
  s_mov_b64 exec, 1
  global_store_dword v13, v14, s[42:43] sc1
  s_mov_b64 exec, -1
  s_waitcnt lgkmcnt(0)
  s_add_u32 m0, s64, 0
  s_nop 0
  buffer_load_dwordx4 v11, s[52:55], s62 offen lds
  s_add_u32 m0, s64, 1024
  s_nop 0
  buffer_load_dwordx4 v12, s[52:55], s62 offen lds
  s_add_u32 s62, s62, 16384
  s_add_u32 m0, s64, 49152
  s_nop 0
  buffer_load_dwordx4 v11, s[52:55], s62 offen lds
  s_add_u32 m0, s64, 50176
  s_nop 0
  buffer_load_dwordx4 v12, s[52:55], s62 offen lds
  s_add_u32 s62, s62, 16384
  s_add_u32 m0, s64, 57344
  s_nop 0
  buffer_load_dwordx4 v11, s[52:55], s62 offen lds
  s_add_u32 m0, s64, 58368
  s_nop 0
  buffer_load_dwordx4 v12, s[52:55], s62 offen lds
  s_add_u32 s62, s62, 16384
  s_add_u32 m0, s64, 8192
  s_nop 0
  buffer_load_dwordx4 v11, s[52:55], s62 offen lds
  s_add_u32 m0, s64, 9216
  s_nop 0
  buffer_load_dwordx4 v12, s[52:55], s62 offen lds
  s_add_u32 s62, s62, 16384
  s_add_u32 m0, s64, 16384
  s_nop 0
  buffer_load_dwordx4 v11, s[52:55], s62 offen lds
  s_add_u32 m0, s64, 17408
  s_nop 0
  buffer_load_dwordx4 v12, s[52:55], s62 offen lds
  s_add_u32 s62, s62, 16384
  s_add_u32 m0, s64, 24576
  s_nop 0
  buffer_load_dwordx4 v11, s[52:55], s62 offen lds
  s_add_u32 m0, s64, 25600
  s_nop 0
  buffer_load_dwordx4 v12, s[52:55], s62 offen lds
  s_add_u32 s62, s62, 16384
  s_add_u32 m0, s64, 65536
  s_nop 0
  buffer_load_dwordx4 v11, s[52:55], s62 offen lds
  s_add_u32 m0, s64, 66560
  s_nop 0
  buffer_load_dwordx4 v12, s[52:55], s62 offen lds
  s_add_u32 s62, s62, 16384
  s_add_u32 m0, s64, 73728
  s_nop 0
  buffer_load_dwordx4 v11, s[52:55], s62 offen lds
  s_add_u32 m0, s64, 74752
  s_nop 0
  buffer_load_dwordx4 v12, s[52:55], s62 offen lds
  s_add_u32 s62, s62, 16384
  s_add_u32 m0, s64, 32768
  s_nop 0
  buffer_load_dwordx4 v11, s[52:55], s62 offen lds
  s_add_u32 m0, s64, 33792
  s_nop 0
  buffer_load_dwordx4 v12, s[52:55], s62 offen lds
  s_add_u32 s62, s62, 16384
  s_add_u32 m0, s64, 40960
  s_nop 0
  buffer_load_dwordx4 v11, s[52:55], s62 offen lds
  s_add_u32 m0, s64, 41984
  s_nop 0
  buffer_load_dwordx4 v12, s[52:55], s62 offen lds
  s_add_u32 s62, s62, 16384
  s_branch L_g2p
L_g2i:
  s_mul_i32 s3, s50, 176128
  s_add_u32 s3, s3, 0x500000
  s_add_u32 s56, s42, s3
  s_addc_u32 s57, s43, 0
  s_and_b32 s57, s57, 0xffff
  s_mov_b32 s58, 176128
  s_mov_b32 s59, 0x20000
  v_lshlrev_b32 v6, 4, v1
  v_add_u32 v7, 88064, v6
  s_lshr_b32 s3, s50, 1
  s_lshl_b32 s3, s3, 6
  s_and_b32 s4, s50, 1
  s_lshl_b32 s4, s4, 1
  s_add_u32 s3, s3, s4
  v_lshrrev_b32 v13, 1, v1
  v_lshlrev_b32 v13, 2, v13
  v_and_b32 v14, 1, v1
  v_add3_u32 v13, v13, v14, s3
  v_lshlrev_b32 v13, 7, v13
  v_add_u32 v19, 0x40000, v13
  s_mov_b32 s8, 0xff
  s_cmp_eq_u32 s45, 1
  s_cselect_b32 s8, 0x7f80, s8
  s_cmp_eq_u32 s45, 2
  s_cselect_b32 s8, 0x3fc000, s8
  s_cmp_eq_u32 s45, 3
  s_cselect_b32 s8, 0x1fe00000, s8
  s_mov_b32 s9, 0
  v_and_b32 v13, 31, v1
  v_lshrrev_b32 v14, 5, v1
  s_lshl_b32 s3, s50, 6
  s_and_b32 s4, s45, 1
  s_lshl_b32 s4, s4, 5
  s_add_u32 s3, s3, s4
  s_lshl_b32 s5, s3, 10
  s_lshl_b32 s4, s51, 7
  s_add_u32 s5, s5, s4
  s_lshr_b32 s4, s45, 1
  s_lshl_b32 s4, s4, 6
  s_add_u32 s5, s5, s4
  v_lshlrev_b32 v10, 10, v13
  v_lshl_add_u32 v10, v14, 4, v10
  v_add_u32 v10, s5, v10
  s_lshl_b32 s3, s3, 3
  s_add_u32 s3, s3, 0x8000
  v_lshl_add_u32 v23, v13, 3, s3
  v_lshrrev_b32 v13, 3, v0
  v_and_b32 v14, 7, v0
  s_lshl_b32 s3, s51, 19
  s_lshl_b32 s4, s50, 8
  s_add_u32 s3, s3, s4
  s_add_u32 s3, s3, 0xb00000
  v_lshlrev_b32 v2, 13, v13
  v_lshl_add_u32 v2, v14, 5, v2
  v_add_u32 v2, s3, v2
  v_add_u32 v21, 262144, v2
  v_and_b32 v13, 7, v13
  v_mul_u32_u24 v3, 144, v13
  v_lshl_add_u32 v3, v14, 4, v3
  s_add_u32 s3, s64, 0x10000
  v_add_u32 v3, s3, v3
  v_add_u32 v22, 8192, v3
L_g2p:
  s_mov_b32 s6, 0
L_hp:
  s_mov_b64 exec, s[8:9]
  global_load_dword v20, v19, s[42:43] sc1
  s_add_u32 s6, s6, 1
  s_waitcnt vmcnt(0) lgkmcnt(0)
  v_cmp_ne_u32 vcc, s49, v20
  s_mov_b64 exec, -1
  s_cmp_ge_u32 s6, 20000
  s_cbranch_scc1 L_hp_ok
  s_cbranch_vccnz L_hp
L_hp_ok:
  s_mov_b32 s65, s63
  buffer_load_dwordx4 v[148:151], v6, s[56:59], s65 offen sc1
  buffer_load_dwordx4 v[152:155], v7, s[56:59], s65 offen sc1
  s_add_u32 s65, s65, 1024
  buffer_load_dwordx4 v[156:159], v6, s[56:59], s65 offen sc1
  buffer_load_dwordx4 v[160:163], v7, s[56:59], s65 offen sc1
  s_add_u32 s65, s65, 1024
  buffer_load_dwordx4 v[164:167], v6, s[56:59], s65 offen sc1
  buffer_load_dwordx4 v[168:171], v7, s[56:59], s65 offen sc1
  s_add_u32 s65, s65, 1024
  buffer_load_dwordx4 v[172:175], v6, s[56:59], s65 offen sc1
  buffer_load_dwordx4 v[176:179], v7, s[56:59], s65 offen sc1
  s_add_u32 s65, s65, 1024
  buffer_load_dwordx4 v[180:183], v6, s[56:59], s65 offen sc1
  buffer_load_dwordx4 v[184:187], v7, s[56:59], s65 offen sc1
  s_add_u32 s65, s65, 1024
  buffer_load_dwordx4 v[56:59], v6, s[56:59], s65 offen sc1
  buffer_load_dwordx4 v[60:63], v7, s[56:59], s65 offen sc1
  s_add_u32 s65, s65, 1024
  buffer_load_dwordx4 v[64:67], v6, s[56:59], s65 offen sc1
  buffer_load_dwordx4 v[68:71], v7, s[56:59], s65 offen sc1
  s_add_u32 s65, s65, 1024
  buffer_load_dwordx4 v[72:75], v6, s[56:59], s65 offen sc1
  buffer_load_dwordx4 v[76:79], v7, s[56:59], s65 offen sc1
  s_add_u32 s65, s65, 1024
  buffer_load_dwordx4 v[80:83], v6, s[56:59], s65 offen sc1
  buffer_load_dwordx4 v[84:87], v7, s[56:59], s65 offen sc1
  s_add_u32 s65, s65, 1024
  buffer_load_dwordx4 v[24:27], v6, s[56:59], s65 offen sc1
  buffer_load_dwordx4 v[28:31], v7, s[56:59], s65 offen sc1
  s_add_u32 s65, s65, 1024
  s_waitcnt vmcnt(18)
  s_cmp_ge_u32 s45, 2
  s_cbranch_scc0 L_g2_sk0
  v_mov_b32 v148, 0
  v_mov_b32 v149, 0
  v_mov_b32 v150, 0
  v_mov_b32 v151, 0
  v_mov_b32 v152, 0
  v_mov_b32 v153, 0
  v_mov_b32 v154, 0
  v_mov_b32 v155, 0
L_g2_sk0:
  v_mfma_f32_32x32x16_bf16 v[192:207], v[88:91], v[148:151], 0
  s_nop 0
  v_mfma_f32_32x32x16_bf16 v[208:223], v[88:91], v[152:155], 0
  v_mfma_f32_32x32x16_bf16 v[224:239], v[92:95], v[148:151], 0
  v_mfma_f32_32x32x16_bf16 v[240:255], v[92:95], v[152:155], 0
  buffer_load_dwordx4 v[148:151], v6, s[56:59], s65 offen sc1
  buffer_load_dwordx4 v[152:155], v7, s[56:59], s65 offen sc1
  s_add_u32 s65, s65, 1024
  s_waitcnt vmcnt(18)
  v_mfma_f32_32x32x16_bf16 v[192:207], v[96:99], v[156:159], v[192:207]
  v_mfma_f32_32x32x16_bf16 v[208:223], v[96:99], v[160:163], v[208:223]
  v_mfma_f32_32x32x16_bf16 v[224:239], v[100:103], v[156:159], v[224:239]
  v_mfma_f32_32x32x16_bf16 v[240:255], v[100:103], v[160:163], v[240:255]
  buffer_load_dwordx4 v[156:159], v6, s[56:59], s65 offen sc1
  buffer_load_dwordx4 v[160:163], v7, s[56:59], s65 offen sc1
  s_add_u32 s65, s65, 1024
  s_waitcnt vmcnt(18)
  v_mfma_f32_32x32x16_bf16 v[192:207], v[104:107], v[164:167], v[192:207]
  v_mfma_f32_32x32x16_bf16 v[208:223], v[104:107], v[168:171], v[208:223]
  v_mfma_f32_32x32x16_bf16 v[224:239], v[108:111], v[164:167], v[224:239]
  v_mfma_f32_32x32x16_bf16 v[240:255], v[108:111], v[168:171], v[240:255]
  buffer_load_dwordx4 v[164:167], v6, s[56:59], s65 offen sc1
  buffer_load_dwordx4 v[168:171], v7, s[56:59], s65 offen sc1
  s_add_u32 s65, s65, 1024
  s_waitcnt vmcnt(18)
  v_mfma_f32_32x32x16_bf16 v[192:207], v[112:115], v[172:175], v[192:207]
  v_mfma_f32_32x32x16_bf16 v[208:223], v[112:115], v[176:179], v[208:223]
  v_mfma_f32_32x32x16_bf16 v[224:239], v[116:119], v[172:175], v[224:239]
  v_mfma_f32_32x32x16_bf16 v[240:255], v[116:119], v[176:179], v[240:255]
  buffer_load_dwordx4 v[172:175], v6, s[56:59], s65 offen sc1
  buffer_load_dwordx4 v[176:179], v7, s[56:59], s65 offen sc1
  s_add_u32 s65, s65, 1024
  s_waitcnt vmcnt(18)
  v_mfma_f32_32x32x16_bf16 v[192:207], v[120:123], v[180:183], v[192:207]
  v_mfma_f32_32x32x16_bf16 v[208:223], v[120:123], v[184:187], v[208:223]
  v_mfma_f32_32x32x16_bf16 v[224:239], v[124:127], v[180:183], v[224:239]
  v_mfma_f32_32x32x16_bf16 v[240:255], v[124:127], v[184:187], v[240:255]
  buffer_load_dwordx4 v[180:183], v6, s[56:59], s65 offen sc1
  buffer_load_dwordx4 v[184:187], v7, s[56:59], s65 offen sc1
  s_add_u32 s65, s65, 1024
  buffer_load_dwordx4 v[120:123], v6, s[56:59], s65 offen sc1
  buffer_load_dwordx4 v[124:127], v7, s[56:59], s65 offen sc1
  s_add_u32 s65, s65, 1024
  s_waitcnt vmcnt(20)
  v_mfma_f32_32x32x16_bf16 v[192:207], v[128:131], v[56:59], v[192:207]
  v_mfma_f32_32x32x16_bf16 v[208:223], v[128:131], v[60:63], v[208:223]
  v_mfma_f32_32x32x16_bf16 v[224:239], v[132:135], v[56:59], v[224:239]
  v_mfma_f32_32x32x16_bf16 v[240:255], v[132:135], v[60:63], v[240:255]
  buffer_load_dwordx4 v[56:59], v6, s[56:59], s65 offen sc1
  buffer_load_dwordx4 v[60:63], v7, s[56:59], s65 offen sc1
  s_add_u32 s65, s65, 1024
  buffer_load_dwordx4 v[128:131], v6, s[56:59], s65 offen sc1
  buffer_load_dwordx4 v[132:135], v7, s[56:59], s65 offen sc1
  s_add_u32 s65, s65, 1024
  s_waitcnt vmcnt(22)
  v_mfma_f32_32x32x16_bf16 v[192:207], v[32:35], v[64:67], v[192:207]
  v_mfma_f32_32x32x16_bf16 v[208:223], v[32:35], v[68:71], v[208:223]
  v_mfma_f32_32x32x16_bf16 v[224:239], v[36:39], v[64:67], v[224:239]
  v_mfma_f32_32x32x16_bf16 v[240:255], v[36:39], v[68:71], v[240:255]
  buffer_load_dwordx4 v[64:67], v6, s[56:59], s65 offen sc1
  buffer_load_dwordx4 v[68:71], v7, s[56:59], s65 offen sc1
  s_add_u32 s65, s65, 1024
  buffer_load_dwordx4 v[32:35], v6, s[56:59], s65 offen sc1
  buffer_load_dwordx4 v[36:39], v7, s[56:59], s65 offen sc1
  s_add_u32 s65, s65, 1024
  s_waitcnt vmcnt(24)
  v_mfma_f32_32x32x16_bf16 v[192:207], v[40:43], v[72:75], v[192:207]
  v_mfma_f32_32x32x16_bf16 v[208:223], v[40:43], v[76:79], v[208:223]
  v_mfma_f32_32x32x16_bf16 v[224:239], v[44:47], v[72:75], v[224:239]
  v_mfma_f32_32x32x16_bf16 v[240:255], v[44:47], v[76:79], v[240:255]
  buffer_load_dwordx4 v[72:75], v6, s[56:59], s65 offen sc1
  buffer_load_dwordx4 v[76:79], v7, s[56:59], s65 offen sc1
  s_add_u32 s65, s65, 1024
  buffer_load_dwordx4 v[40:43], v6, s[56:59], s65 offen sc1
  buffer_load_dwordx4 v[44:47], v7, s[56:59], s65 offen sc1
  s_add_u32 s65, s65, 1024
  s_waitcnt vmcnt(26)
  v_mfma_f32_32x32x16_bf16 v[192:207], v[48:51], v[80:83], v[192:207]
  v_mfma_f32_32x32x16_bf16 v[208:223], v[48:51], v[84:87], v[208:223]
  v_mfma_f32_32x32x16_bf16 v[224:239], v[52:55], v[80:83], v[224:239]
  v_mfma_f32_32x32x16_bf16 v[240:255], v[52:55], v[84:87], v[240:255]
  s_waitcnt vmcnt(24)
  v_mfma_f32_32x32x16_bf16 v[192:207], v[140:143], v[24:27], v[192:207]
  ds_read_b64_tr_b16 v[88:89], v8 offset:0
  v_mfma_f32_32x32x16_bf16 v[208:223], v[140:143], v[28:31], v[208:223]
  ds_read_b64_tr_b16 v[90:91], v8 offset:1024
  v_mfma_f32_32x32x16_bf16 v[224:239], v[144:147], v[24:27], v[224:239]
  ds_read_b64_tr_b16 v[92:93], v9 offset:0
  v_mfma_f32_32x32x16_bf16 v[240:255], v[144:147], v[28:31], v[240:255]
  ds_read_b64_tr_b16 v[94:95], v9 offset:1024
  s_waitcnt vmcnt(22)
  s_waitcnt lgkmcnt(0)
  v_mfma_f32_32x32x16_bf16 v[192:207], v[88:91], v[148:151], v[192:207]
  ds_read_b64_tr_b16 v[96:97], v8 offset:49152
  v_mfma_f32_32x32x16_bf16 v[208:223], v[88:91], v[152:155], v[208:223]
  ds_read_b64_tr_b16 v[98:99], v8 offset:50176
  v_mfma_f32_32x32x16_bf16 v[224:239], v[92:95], v[148:151], v[224:239]
  ds_read_b64_tr_b16 v[100:101], v9 offset:49152
  v_mfma_f32_32x32x16_bf16 v[240:255], v[92:95], v[152:155], v[240:255]
  ds_read_b64_tr_b16 v[102:103], v9 offset:50176
  s_add_u32 m0, s64, 0
  s_nop 0
  buffer_load_dwordx4 v11, s[52:55], s62 offen lds
  s_add_u32 m0, s64, 1024
  s_nop 0
  buffer_load_dwordx4 v12, s[52:55], s62 offen lds
  s_add_u32 s62, s62, 16384
  s_waitcnt vmcnt(22)
  s_waitcnt lgkmcnt(0)
  v_mfma_f32_32x32x16_bf16 v[192:207], v[96:99], v[156:159], v[192:207]
  ds_read_b64_tr_b16 v[88:89], v8 offset:57344
  v_mfma_f32_32x32x16_bf16 v[208:223], v[96:99], v[160:163], v[208:223]
  ds_read_b64_tr_b16 v[90:91], v8 offset:58368
  v_mfma_f32_32x32x16_bf16 v[224:239], v[100:103], v[156:159], v[224:239]
  ds_read_b64_tr_b16 v[92:93], v9 offset:57344
  v_mfma_f32_32x32x16_bf16 v[240:255], v[100:103], v[160:163], v[240:255]
  ds_read_b64_tr_b16 v[94:95], v9 offset:58368
  s_add_u32 m0, s64, 49152
  s_nop 0
  buffer_load_dwordx4 v11, s[52:55], s62 offen lds
  s_add_u32 m0, s64, 50176
  s_nop 0
  buffer_load_dwordx4 v12, s[52:55], s62 offen lds
  s_add_u32 s62, s62, 16384
  s_waitcnt vmcnt(22)
  s_waitcnt lgkmcnt(0)
  v_mfma_f32_32x32x16_bf16 v[192:207], v[88:91], v[164:167], v[192:207]
  ds_read_b64_tr_b16 v[96:97], v8 offset:8192
  v_mfma_f32_32x32x16_bf16 v[208:223], v[88:91], v[168:171], v[208:223]
  ds_read_b64_tr_b16 v[98:99], v8 offset:9216
  v_mfma_f32_32x32x16_bf16 v[224:239], v[92:95], v[164:167], v[224:239]
  ds_read_b64_tr_b16 v[100:101], v9 offset:8192
  v_mfma_f32_32x32x16_bf16 v[240:255], v[92:95], v[168:171], v[240:255]
  ds_read_b64_tr_b16 v[102:103], v9 offset:9216
  s_waitcnt vmcnt(20)
  s_waitcnt lgkmcnt(0)
  v_mfma_f32_32x32x16_bf16 v[192:207], v[96:99], v[172:175], v[192:207]
  ds_read_b64_tr_b16 v[88:89], v8 offset:16384
  v_mfma_f32_32x32x16_bf16 v[208:223], v[96:99], v[176:179], v[208:223]
  ds_read_b64_tr_b16 v[90:91], v8 offset:17408
  v_mfma_f32_32x32x16_bf16 v[224:239], v[100:103], v[172:175], v[224:239]
  ds_read_b64_tr_b16 v[92:93], v9 offset:16384
  v_mfma_f32_32x32x16_bf16 v[240:255], v[100:103], v[176:179], v[240:255]
  ds_read_b64_tr_b16 v[94:95], v9 offset:17408
  global_load_dwordx4 v[104:107], v10, s[16:17]
  global_load_dwordx4 v[108:111], v10, s[16:17] offset:32
  global_load_dword v23, v23, s[42:43] sc1
  s_waitcnt vmcnt(21)
  s_waitcnt lgkmcnt(0)
  v_mfma_f32_32x32x16_bf16 v[192:207], v[88:91], v[180:183], v[192:207]
  ds_read_b64_tr_b16 v[96:97], v8 offset:24576
  v_mfma_f32_32x32x16_bf16 v[208:223], v[88:91], v[184:187], v[208:223]
  ds_read_b64_tr_b16 v[98:99], v8 offset:25600
  v_mfma_f32_32x32x16_bf16 v[224:239], v[92:95], v[180:183], v[224:239]
  ds_read_b64_tr_b16 v[100:101], v9 offset:24576
  v_mfma_f32_32x32x16_bf16 v[240:255], v[92:95], v[184:187], v[240:255]
  ds_read_b64_tr_b16 v[102:103], v9 offset:25600
  s_waitcnt vmcnt(19)
  s_waitcnt lgkmcnt(0)
  v_mfma_f32_32x32x16_bf16 v[192:207], v[96:99], v[120:123], v[192:207]
  ds_read_b64_tr_b16 v[88:89], v4 offset:0
  v_mfma_f32_32x32x16_bf16 v[208:223], v[96:99], v[124:127], v[208:223]
  ds_read_b64_tr_b16 v[90:91], v4 offset:1024
  v_mfma_f32_32x32x16_bf16 v[224:239], v[100:103], v[120:123], v[224:239]
  ds_read_b64_tr_b16 v[92:93], v5 offset:0
  v_mfma_f32_32x32x16_bf16 v[240:255], v[100:103], v[124:127], v[240:255]
  ds_read_b64_tr_b16 v[94:95], v5 offset:1024
  s_waitcnt vmcnt(17)
  s_waitcnt lgkmcnt(0)
  v_mfma_f32_32x32x16_bf16 v[192:207], v[88:91], v[56:59], v[192:207]
  ds_read_b64_tr_b16 v[96:97], v4 offset:8192
  v_mfma_f32_32x32x16_bf16 v[208:223], v[88:91], v[60:63], v[208:223]
  ds_read_b64_tr_b16 v[98:99], v4 offset:9216
  v_mfma_f32_32x32x16_bf16 v[224:239], v[92:95], v[56:59], v[224:239]
  ds_read_b64_tr_b16 v[100:101], v5 offset:8192
  v_mfma_f32_32x32x16_bf16 v[240:255], v[92:95], v[60:63], v[240:255]
  ds_read_b64_tr_b16 v[102:103], v5 offset:9216
  global_load_dwordx4 v[80:83], v2, s[42:43] sc1
  global_load_dwordx4 v[84:87], v2, s[42:43] offset:16 sc1
  global_load_dwordx4 v[24:27], v21, s[42:43] sc1
  global_load_dwordx4 v[28:31], v21, s[42:43] offset:16 sc1
  s_waitcnt vmcnt(19)
  s_waitcnt lgkmcnt(0)
  v_mfma_f32_32x32x16_bf16 v[192:207], v[96:99], v[128:131], v[192:207]
  ds_read_b64_tr_b16 v[88:89], v8 offset:32768
  v_mfma_f32_32x32x16_bf16 v[208:223], v[96:99], v[132:135], v[208:223]
  ds_read_b64_tr_b16 v[90:91], v8 offset:33792
  v_mfma_f32_32x32x16_bf16 v[224:239], v[100:103], v[128:131], v[224:239]
  ds_read_b64_tr_b16 v[92:93], v9 offset:32768
  v_mfma_f32_32x32x16_bf16 v[240:255], v[100:103], v[132:135], v[240:255]
  ds_read_b64_tr_b16 v[94:95], v9 offset:33792
  s_waitcnt vmcnt(17)
  s_waitcnt lgkmcnt(0)
  v_mfma_f32_32x32x16_bf16 v[192:207], v[88:91], v[64:67], v[192:207]
  ds_read_b64_tr_b16 v[96:97], v8 offset:40960
  v_mfma_f32_32x32x16_bf16 v[208:223], v[88:91], v[68:71], v[208:223]
  ds_read_b64_tr_b16 v[98:99], v8 offset:41984
  v_mfma_f32_32x32x16_bf16 v[224:239], v[92:95], v[64:67], v[224:239]
  ds_read_b64_tr_b16 v[100:101], v9 offset:40960
  v_mfma_f32_32x32x16_bf16 v[240:255], v[92:95], v[68:71], v[240:255]
  ds_read_b64_tr_b16 v[102:103], v9 offset:41984
  s_waitcnt vmcnt(9)
  s_waitcnt lgkmcnt(0)
  v_mfma_f32_32x32x16_bf16 v[192:207], v[96:99], v[32:35], v[192:207]
  ds_read_b64_tr_b16 v[88:89], v8 offset:0
  v_mfma_f32_32x32x16_bf16 v[208:223], v[96:99], v[36:39], v[208:223]
  ds_read_b64_tr_b16 v[90:91], v8 offset:1024
  v_mfma_f32_32x32x16_bf16 v[224:239], v[100:103], v[32:35], v[224:239]
  ds_read_b64_tr_b16 v[92:93], v9 offset:0
  v_mfma_f32_32x32x16_bf16 v[240:255], v[100:103], v[36:39], v[240:255]
  ds_read_b64_tr_b16 v[94:95], v9 offset:1024
  s_waitcnt vmcnt(7)
  s_waitcnt lgkmcnt(0)
  v_mfma_f32_32x32x16_bf16 v[192:207], v[88:91], v[72:75], v[192:207]
  ds_read_b64_tr_b16 v[96:97], v8 offset:49152
  v_mfma_f32_32x32x16_bf16 v[208:223], v[88:91], v[76:79], v[208:223]
  ds_read_b64_tr_b16 v[98:99], v8 offset:50176
  v_mfma_f32_32x32x16_bf16 v[224:239], v[92:95], v[72:75], v[224:239]
  ds_read_b64_tr_b16 v[100:101], v9 offset:49152
  v_mfma_f32_32x32x16_bf16 v[240:255], v[92:95], v[76:79], v[240:255]
  ds_read_b64_tr_b16 v[102:103], v9 offset:50176
  s_waitcnt vmcnt(11)
  s_waitcnt lgkmcnt(0)
  v_mfma_f32_32x32x16_bf16 v[192:207], v[96:99], v[40:43], v[192:207]
  v_mfma_f32_32x32x16_bf16 v[208:223], v[96:99], v[44:47], v[208:223]
  v_mfma_f32_32x32x16_bf16 v[224:239], v[100:103], v[40:43], v[224:239]
  v_mfma_f32_32x32x16_bf16 v[240:255], v[100:103], v[44:47], v[240:255]
  s_waitcnt vmcnt(0)
  v_xor_b32 v13, v80, v82
  v_xor_b32 v14, v81, v83
  v_xor_b32 v15, v84, v86
  v_xor_b32 v16, v85, v87
  v_xor_b32 v17, v24, v26
  v_xor_b32 v18, v25, v27
  v_min3_u32 v20, v13, v14, v15
  v_max3_u32 v13, v13, v14, v15
  v_xor_b32 v14, v28, v30
  v_xor_b32 v15, v29, v31
  v_min3_u32 v20, v20, v16, v17
  v_max3_u32 v13, v13, v16, v17
  v_min3_u32 v20, v20, v18, v14
  v_max3_u32 v13, v13, v18, v14
  v_min_u32 v20, v20, v15
  v_max_u32 v13, v13, v15
  v_cmp_ne_u32 vcc, s49, v20
  v_cmp_ne_u32 s[4:5], s49, v13
  s_nop 0
  s_or_b64 vcc, vcc, s[4:5]
  s_cbranch_vccnz L_ao_slow
L_ao_ok:
  ds_write2_b64 v3, v[80:81], v[84:85] offset0:0 offset1:1
  ds_write2_b64 v22, v[24:25], v[28:29] offset0:0 offset1:1
  v_lshl_add_u32 v18, v1, 4, s64
  s_cmp_eq_u32 s45, 0
  s_cbranch_scc1 L_ew0_own
  ds_write_b128 v18, v[192:195] offset:0
  ds_write_b128 v18, v[196:199] offset:1024
  ds_write_b128 v18, v[200:203] offset:8192
  ds_write_b128 v18, v[204:207] offset:9216
  s_branch L_ew0_e
L_ew0_own:
  v_mov_b32 v32, v192
  v_mov_b32 v33, v193
  v_mov_b32 v34, v194
  v_mov_b32 v35, v195
  v_mov_b32 v36, v196
  v_mov_b32 v37, v197
  v_mov_b32 v38, v198
  v_mov_b32 v39, v199
  v_mov_b32 v40, v200
  v_mov_b32 v41, v201
  v_mov_b32 v42, v202
  v_mov_b32 v43, v203
  v_mov_b32 v44, v204
  v_mov_b32 v45, v205
  v_mov_b32 v46, v206
  v_mov_b32 v47, v207
L_ew0_e:
  v_and_b32 v23, 0xffff0000, v23
  v_rcp_f32 v23, v23
  s_lshl_b32 s3, s45, 14
  v_mul_f32 v23, v23, v23
  s_add_u32 s4, s45, 1
  s_and_b32 s4, s4, 3
  s_lshl_b32 s4, s4, 11
  s_add_u32 s4, s4, s3
  v_lshl_add_u32 v13, v1, 4, s4
  s_cmp_eq_u32 s45, 1
  s_cbranch_scc1 L_ew1_own
  ds_write_b128 v18, v[208:211] offset:16384
  ds_write_b128 v18, v[212:215] offset:17408
  ds_write_b128 v18, v[216:219] offset:24576
  ds_write_b128 v18, v[220:223] offset:25600
  s_branch L_ew1_e
L_ew1_own:
  v_mov_b32 v32, v208
  v_mov_b32 v33, v209
  v_mov_b32 v34, v210
  v_mov_b32 v35, v211
  v_mov_b32 v36, v212
  v_mov_b32 v37, v213
  v_mov_b32 v38, v214
  v_mov_b32 v39, v215
  v_mov_b32 v40, v216
  v_mov_b32 v41, v217
  v_mov_b32 v42, v218
  v_mov_b32 v43, v219
  v_mov_b32 v44, v220
  v_mov_b32 v45, v221
  v_mov_b32 v46, v222
  v_mov_b32 v47, v223
L_ew1_e:
  s_add_u32 s4, s45, 2
  s_and_b32 s4, s4, 3
  s_lshl_b32 s4, s4, 11
  s_add_u32 s4, s4, s3
  v_lshl_add_u32 v14, v1, 4, s4
  s_add_u32 s4, s45, 3
  s_and_b32 s4, s4, 3
  s_lshl_b32 s4, s4, 11
  s_add_u32 s4, s4, s3
  v_lshl_add_u32 v15, v1, 4, s4
  s_cmp_eq_u32 s45, 2
  s_cbranch_scc1 L_ew2_own
  ds_write_b128 v18, v[224:227] offset:32768
  ds_write_b128 v18, v[228:231] offset:33792
  ds_write_b128 v18, v[232:235] offset:40960
  ds_write_b128 v18, v[236:239] offset:41984
  s_branch L_ew2_e
L_ew2_own:
  v_mov_b32 v32, v224
  v_mov_b32 v33, v225
  v_mov_b32 v34, v226
  v_mov_b32 v35, v227
  v_mov_b32 v36, v228
  v_mov_b32 v37, v229
  v_mov_b32 v38, v230
  v_mov_b32 v39, v231
  v_mov_b32 v40, v232
  v_mov_b32 v41, v233
  v_mov_b32 v42, v234
  v_mov_b32 v43, v235
  v_mov_b32 v44, v236
  v_mov_b32 v45, v237
  v_mov_b32 v46, v238
  v_mov_b32 v47, v239
L_ew2_e:
  v_bfe_u32 v16, v1, 2, 2
  v_mul_u32_u24 v16, 144, v16
  v_lshrrev_b32 v17, 5, v1
  v_lshl_add_u32 v16, v17, 11, v16
  v_bfe_u32 v17, v1, 4, 1
  v_lshl_add_u32 v16, v17, 5, v16
  v_and_b32 v17, 3, v1
  v_lshl_add_u32 v16, v17, 3, v16
  s_cmp_eq_u32 s45, 3
  s_cbranch_scc1 L_ew3_own
  ds_write_b128 v18, v[240:243] offset:49152
  ds_write_b128 v18, v[244:247] offset:50176
  ds_write_b128 v18, v[248:251] offset:57344
  ds_write_b128 v18, v[252:255] offset:58368
  s_branch L_ew3_e
L_ew3_own:
  v_mov_b32 v32, v240
  v_mov_b32 v33, v241
  v_mov_b32 v34, v242
  v_mov_b32 v35, v243
  v_mov_b32 v36, v244
  v_mov_b32 v37, v245
  v_mov_b32 v38, v246
  v_mov_b32 v39, v247
  v_mov_b32 v40, v248
  v_mov_b32 v41, v249
  v_mov_b32 v42, v250
  v_mov_b32 v43, v251
  v_mov_b32 v44, v252
  v_mov_b32 v45, v253
  v_mov_b32 v46, v254
  v_mov_b32 v47, v255
L_ew3_e:
  s_lshr_b32 s3, s45, 1
  s_lshl_b32 s3, s3, 13
  s_and_b32 s4, s45, 1
  s_lshl_b32 s4, s4, 6
  s_add_u32 s3, s3, s4
  s_add_u32 s3, s3, 0x10000
  v_add_u32 v16, s3, v16
  s_waitcnt lgkmcnt(0)
  s_barrier
  ds_read_b64_tr_b16 v[88:89], v16 offset:0
  ds_read_b64_tr_b16 v[90:91], v16 offset:576
  ds_read_b64_tr_b16 v[92:93], v16 offset:4096
  ds_read_b64_tr_b16 v[94:95], v16 offset:4672
  ds_read_b128 v[112:115], v13 offset:0
  ds_read_b128 v[128:131], v14 offset:0
  ds_read_b128 v[144:147], v15 offset:0
  ds_read_b128 v[116:119], v13 offset:1024
  ds_read_b128 v[132:135], v14 offset:1024
  ds_read_b128 v[148:151], v15 offset:1024
  s_waitcnt lgkmcnt(6)
  ds_read_b128 v[120:123], v13 offset:8192
  v_lshlrev_b32 v160, 16, v104
  v_and_b32 v161, 0xffff0000, v104
  v_lshlrev_b32 v162, 16, v105
  v_and_b32 v163, 0xffff0000, v105
  v_lshlrev_b32 v164, 16, v106
  v_and_b32 v165, 0xffff0000, v106
  v_lshlrev_b32 v166, 16, v107
  v_and_b32 v167, 0xffff0000, v107
  ds_read_b128 v[136:139], v14 offset:8192
  v_lshlrev_b32 v168, 16, v108
  v_and_b32 v169, 0xffff0000, v108
  v_lshlrev_b32 v170, 16, v109
  v_and_b32 v171, 0xffff0000, v109
  v_lshlrev_b32 v172, 16, v110
  v_and_b32 v173, 0xffff0000, v110
  v_lshlrev_b32 v174, 16, v111
  v_and_b32 v175, 0xffff0000, v111
  ds_read_b128 v[152:155], v15 offset:8192
  v_lshlrev_b32 v176, 16, v88
  v_and_b32 v177, 0xffff0000, v88
  v_lshlrev_b32 v178, 16, v89
  v_and_b32 v179, 0xffff0000, v89
  v_lshlrev_b32 v180, 16, v90
  v_and_b32 v181, 0xffff0000, v90
  v_lshlrev_b32 v182, 16, v91
  v_and_b32 v183, 0xffff0000, v91
  ds_read_b128 v[124:127], v13 offset:9216
  v_lshlrev_b32 v184, 16, v92
  v_and_b32 v185, 0xffff0000, v92
  v_lshlrev_b32 v186, 16, v93
  v_and_b32 v187, 0xffff0000, v93
  v_lshlrev_b32 v188, 16, v94
  v_and_b32 v189, 0xffff0000, v94
  v_lshlrev_b32 v190, 16, v95
  v_and_b32 v191, 0xffff0000, v95
  ds_read_b128 v[140:143], v14 offset:9216
  v_add_f32 v160, v160, v176
  v_add_f32 v161, v161, v177
  v_add_f32 v162, v162, v178
  v_add_f32 v163, v163, v179
  v_add_f32 v164, v164, v180
  v_add_f32 v165, v165, v181
  v_add_f32 v166, v166, v182
  v_add_f32 v167, v167, v183
  v_add_f32 v168, v168, v184
  v_add_f32 v169, v169, v185
  v_add_f32 v170, v170, v186
  v_add_f32 v171, v171, v187
  v_add_f32 v172, v172, v188
  v_add_f32 v173, v173, v189
  v_add_f32 v174, v174, v190
  v_add_f32 v175, v175, v191
  ds_read_b128 v[156:159], v15 offset:9216
  v_cvt_pk_bf16_f32 v176, v160, v161
  v_cvt_pk_bf16_f32 v178, v162, v163
  v_cvt_pk_bf16_f32 v180, v164, v165
  v_cvt_pk_bf16_f32 v182, v166, v167
  v_cvt_pk_bf16_f32 v184, v168, v169
  v_cvt_pk_bf16_f32 v186, v170, v171
  v_cvt_pk_bf16_f32 v188, v172, v173
  v_cvt_pk_bf16_f32 v190, v174, v175
  v_lshlrev_b32 v160, 16, v176
  v_and_b32 v161, 0xffff0000, v176
  v_lshlrev_b32 v162, 16, v178
  v_and_b32 v163, 0xffff0000, v178
  v_lshlrev_b32 v164, 16, v180
  v_and_b32 v165, 0xffff0000, v180
  v_lshlrev_b32 v166, 16, v182
  v_and_b32 v167, 0xffff0000, v182
  v_lshlrev_b32 v168, 16, v184
  v_and_b32 v169, 0xffff0000, v184
  v_lshlrev_b32 v170, 16, v186
  v_and_b32 v171, 0xffff0000, v186
  v_lshlrev_b32 v172, 16, v188
  v_and_b32 v173, 0xffff0000, v188
  v_lshlrev_b32 v174, 16, v190
  v_and_b32 v175, 0xffff0000, v190
  s_waitcnt lgkmcnt(9)
  v_add_f32 v32, v32, v112
  v_add_f32 v33, v33, v113
  v_add_f32 v128, v128, v144
  v_add_f32 v129, v129, v145
  v_add_f32 v34, v34, v114
  v_add_f32 v35, v35, v115
  v_add_f32 v130, v130, v146
  v_add_f32 v131, v131, v147
  v_add_f32 v32, v32, v128
  v_add_f32 v33, v33, v129
  v_add_f32 v34, v34, v130
  v_add_f32 v35, v35, v131
  v_mul_f32 v32, v32, v23
  v_mul_f32 v33, v33, v23
  v_mul_f32 v34, v34, v23
  v_mul_f32 v35, v35, v23
  v_cvt_pk_bf16_f32 v176, v32, v33
  v_cvt_pk_bf16_f32 v177, v34, v35
  s_waitcnt lgkmcnt(6)
  v_add_f32 v36, v36, v116
  v_add_f32 v37, v37, v117
  v_add_f32 v132, v132, v148
  v_add_f32 v133, v133, v149
  v_add_f32 v38, v38, v118
  v_add_f32 v39, v39, v119
  v_add_f32 v134, v134, v150
  v_add_f32 v135, v135, v151
  v_add_f32 v36, v36, v132
  v_add_f32 v37, v37, v133
  v_add_f32 v38, v38, v134
  v_add_f32 v39, v39, v135
  v_mul_f32 v36, v36, v23
  v_mul_f32 v37, v37, v23
  v_mul_f32 v38, v38, v23
  v_mul_f32 v39, v39, v23
  v_cvt_pk_bf16_f32 v178, v36, v37
  v_cvt_pk_bf16_f32 v179, v38, v39
  s_nop 1
  v_permlane32_swap_b32 v176, v178
  v_permlane32_swap_b32 v177, v179
  s_nop 1
  v_lshlrev_b32 v184, 16, v176
  v_and_b32 v185, 0xffff0000, v176
  v_lshlrev_b32 v186, 16, v177
  v_and_b32 v187, 0xffff0000, v177
  v_lshlrev_b32 v188, 16, v178
  v_and_b32 v189, 0xffff0000, v178
  v_lshlrev_b32 v190, 16, v179
  v_and_b32 v191, 0xffff0000, v179
  v_add_f32 v184, v184, v160
  v_add_f32 v185, v185, v161
  v_add_f32 v186, v186, v162
  v_add_f32 v187, v187, v163
  v_add_f32 v188, v188, v164
  v_add_f32 v189, v189, v165
  v_add_f32 v190, v190, v166
  v_add_f32 v191, v191, v167
  v_cvt_pk_bf16_f32 v104, v184, v185
  v_cvt_pk_bf16_f32 v105, v186, v187
  v_cvt_pk_bf16_f32 v106, v188, v189
  v_cvt_pk_bf16_f32 v107, v190, v191
  global_store_dwordx4 v10, v[104:107], s[38:39] offset:0
  s_waitcnt lgkmcnt(3)
  v_add_f32 v40, v40, v120
  v_add_f32 v41, v41, v121
  v_add_f32 v136, v136, v152
  v_add_f32 v137, v137, v153
  v_add_f32 v42, v42, v122
  v_add_f32 v43, v43, v123
  v_add_f32 v138, v138, v154
  v_add_f32 v139, v139, v155
  v_add_f32 v40, v40, v136
  v_add_f32 v41, v41, v137
  v_add_f32 v42, v42, v138
  v_add_f32 v43, v43, v139
  v_mul_f32 v40, v40, v23
  v_mul_f32 v41, v41, v23
  v_mul_f32 v42, v42, v23
  v_mul_f32 v43, v43, v23
  v_cvt_pk_bf16_f32 v180, v40, v41
  v_cvt_pk_bf16_f32 v181, v42, v43
  s_waitcnt lgkmcnt(0)
  v_add_f32 v44, v44, v124
  v_add_f32 v45, v45, v125
  v_add_f32 v140, v140, v156
  v_add_f32 v141, v141, v157
  v_add_f32 v46, v46, v126
  v_add_f32 v47, v47, v127
  v_add_f32 v142, v142, v158
  v_add_f32 v143, v143, v159
  v_add_f32 v44, v44, v140
  v_add_f32 v45, v45, v141
  v_add_f32 v46, v46, v142
  v_add_f32 v47, v47, v143
  v_mul_f32 v44, v44, v23
  v_mul_f32 v45, v45, v23
  v_mul_f32 v46, v46, v23
  v_mul_f32 v47, v47, v23
  v_cvt_pk_bf16_f32 v182, v44, v45
  v_cvt_pk_bf16_f32 v183, v46, v47
  s_nop 1
  v_permlane32_swap_b32 v180, v182
  v_permlane32_swap_b32 v181, v183
  s_nop 1
  v_lshlrev_b32 v184, 16, v180
  v_and_b32 v185, 0xffff0000, v180
  v_lshlrev_b32 v186, 16, v181
  v_and_b32 v187, 0xffff0000, v181
  v_lshlrev_b32 v188, 16, v182
  v_and_b32 v189, 0xffff0000, v182
  v_lshlrev_b32 v190, 16, v183
  v_and_b32 v191, 0xffff0000, v183
  v_add_f32 v184, v184, v168
  v_add_f32 v185, v185, v169
  v_add_f32 v186, v186, v170
  v_add_f32 v187, v187, v171
  v_add_f32 v188, v188, v172
  v_add_f32 v189, v189, v173
  v_add_f32 v190, v190, v174
  v_add_f32 v191, v191, v175
  v_cvt_pk_bf16_f32 v108, v184, v185
  v_cvt_pk_bf16_f32 v109, v186, v187
  v_cvt_pk_bf16_f32 v110, v188, v189
  v_cvt_pk_bf16_f32 v111, v190, v191
  global_store_dwordx4 v10, v[108:111], s[38:39] offset:32
  s_branch L_done
L_ao_slow:
  s_mov_b32 s6, 0
L_ao_spin:
  s_sleep 1
  global_load_dwordx4 v[80:83], v2, s[42:43] sc1
  global_load_dwordx4 v[84:87], v2, s[42:43] offset:16 sc1
  global_load_dwordx4 v[24:27], v21, s[42:43] sc1
  global_load_dwordx4 v[28:31], v21, s[42:43] offset:16 sc1
  s_add_u32 s6, s6, 1
  s_waitcnt vmcnt(0)
  v_xor_b32 v13, v80, v82
  v_xor_b32 v14, v81, v83
  v_xor_b32 v15, v84, v86
  v_xor_b32 v16, v85, v87
  v_xor_b32 v17, v24, v26
  v_xor_b32 v18, v25, v27
  v_min3_u32 v20, v13, v14, v15
  v_max3_u32 v13, v13, v14, v15
  v_xor_b32 v14, v28, v30
  v_xor_b32 v15, v29, v31
  v_min3_u32 v20, v20, v16, v17
  v_max3_u32 v13, v13, v16, v17
  v_min3_u32 v20, v20, v18, v14
  v_max3_u32 v13, v13, v18, v14
  v_min_u32 v20, v20, v15
  v_max_u32 v13, v13, v15
  v_cmp_ne_u32 vcc, s49, v20
  v_cmp_ne_u32 s[4:5], s49, v13
  s_nop 0
  s_or_b64 vcc, vcc, s[4:5]
  s_cmp_ge_u32 s6, 20000
  s_cbranch_scc1 L_ao_ok
  s_cbranch_vccnz L_ao_spin
  s_branch L_ao_ok
L_late_slow:
  s_mov_b32 s6, 0
L_late_spin:
  s_sleep 2
  global_load_dwordx2 v[18:19], v2, s[42:43] sc1
  global_load_dwordx2 v[20:21], v2, s[42:43] offset:256 sc1
  global_load_dwordx4 v[128:131], v3, s[42:43] offset:0 sc1
  global_load_dwordx4 v[132:135], v3, s[42:43] offset:1024 sc1
  global_load_dwordx4 v[136:139], v3, s[42:43] offset:2048 sc1
  s_add_u32 s6, s6, 1
  s_waitcnt vmcnt(0)
  v_xor_b32 v26, v18, v19
  v_xor_b32 v27, v20, v21
  v_xor_b32 v28, v128, v129
  v_xor_b32 v29, v130, v131
  v_xor_b32 v30, v132, v133
  v_xor_b32 v31, v134, v135
  v_min3_u32 v23, v26, v27, v28
  v_max3_u32 v26, v26, v27, v28
  v_min3_u32 v23, v23, v29, v30
  v_max3_u32 v26, v26, v29, v30
  v_xor_b32 v27, v136, v137
  v_xor_b32 v28, v138, v139
  v_min3_u32 v23, v23, v31, v27
  v_max3_u32 v26, v26, v31, v27
  v_min_u32 v23, v23, v28
  v_max_u32 v26, v26, v28
  v_cmp_ne_u32 vcc, s49, v23
  v_cmp_ne_u32 s[4:5], s49, v26
  s_nop 0
  s_or_b64 vcc, vcc, s[4:5]
  s_cmp_ge_u32 s6, 20000
  s_cbranch_scc1 L_late_ok
  s_cbranch_vccnz L_late_spin
  s_branch L_late_ok
L_idle:
  v_mov_b32 v26, 0
  global_load_dword v25, v26, s[42:43] sc1
  s_lshr_b32 s3, s46, 3
  s_mul_i32 s3, s3, 344
  s_mul_i32 s4, s45, 86
  s_add_u32 s3, s3, s4
  s_lshl_b32 s3, s3, 7
  v_lshlrev_b32 v158, 7, v1
  v_add_u32 v158, s3, v158
  global_load_dword v159, v158, s[36:37]
  v_add_u32 v27, 8192, v158
  s_mov_b64 exec, 0x3fffff
  global_load_dword v159, v27, s[36:37]
  s_mov_b64 exec, -1
  s_lshl_b32 s3, s51, 7
  s_add_u32 s52, s36, s3
  s_addc_u32 s53, s37, 0
  s_and_b32 s53, s53, 0xffff
  s_sub_u32 s54, 1409024, s3
  s_mov_b32 s55, 0x20000
  s_mul_i32 s3, s45, 22
  s_cmp_ge_u32 s45, 2
  s_subb_u32 s3, s3, 0
  s_cmp_ge_u32 s45, 3
  s_subb_u32 s3, s3, 0
  s_lshl_b32 s62, s3, 14
  s_lshl_b32 s63, s3, 10
  s_lshl_b32 s64, s45, 11
  v_lshrrev_b32 v26, 3, v1
  v_and_b32 v27, 7, v1
  v_bfe_u32 v28, v1, 4, 1
  v_lshlrev_b32 v28, 2, v28
  v_xor_b32 v27, v27, v28
  v_lshlrev_b32 v27, 4, v27
  v_lshl_add_u32 v11, v26, 10, v27
  v_add_u32 v12, 8192, v11
  s_add_u32 m0, s64, 0
  s_nop 0
  buffer_load_dwordx4 v11, s[52:55], s62 offen lds
  s_add_u32 m0, s64, 1024
  s_nop 0
  buffer_load_dwordx4 v12, s[52:55], s62 offen lds
  s_add_u32 s62, s62, 16384
  s_add_u32 m0, s64, 49152
  s_nop 0
  buffer_load_dwordx4 v11, s[52:55], s62 offen lds
  s_add_u32 m0, s64, 50176
  s_nop 0
  buffer_load_dwordx4 v12, s[52:55], s62 offen lds
  s_add_u32 s62, s62, 16384
  s_add_u32 m0, s64, 57344
  s_nop 0
  buffer_load_dwordx4 v11, s[52:55], s62 offen lds
  s_add_u32 m0, s64, 58368
  s_nop 0
  buffer_load_dwordx4 v12, s[52:55], s62 offen lds
  s_add_u32 s62, s62, 16384
  s_add_u32 m0, s64, 8192
  s_nop 0
  buffer_load_dwordx4 v11, s[52:55], s62 offen lds
  s_add_u32 m0, s64, 9216
  s_nop 0
  buffer_load_dwordx4 v12, s[52:55], s62 offen lds
  s_add_u32 s62, s62, 16384
  s_add_u32 m0, s64, 16384
  s_nop 0
  buffer_load_dwordx4 v11, s[52:55], s62 offen lds
  s_add_u32 m0, s64, 17408
  s_nop 0
  buffer_load_dwordx4 v12, s[52:55], s62 offen lds
  s_add_u32 s62, s62, 16384
  s_add_u32 m0, s64, 24576
  s_nop 0
  buffer_load_dwordx4 v11, s[52:55], s62 offen lds
  s_add_u32 m0, s64, 25600
  s_nop 0
  buffer_load_dwordx4 v12, s[52:55], s62 offen lds
  s_add_u32 s62, s62, 16384
  s_add_u32 m0, s64, 65536
  s_nop 0
  buffer_load_dwordx4 v11, s[52:55], s62 offen lds
  s_add_u32 m0, s64, 66560
  s_nop 0
  buffer_load_dwordx4 v12, s[52:55], s62 offen lds
  s_add_u32 s62, s62, 16384
  s_add_u32 m0, s64, 73728
  s_nop 0
  buffer_load_dwordx4 v11, s[52:55], s62 offen lds
  s_add_u32 m0, s64, 74752
  s_nop 0
  buffer_load_dwordx4 v12, s[52:55], s62 offen lds
  s_add_u32 s62, s62, 16384
  s_add_u32 m0, s64, 32768
  s_nop 0
  buffer_load_dwordx4 v11, s[52:55], s62 offen lds
  s_add_u32 m0, s64, 33792
  s_nop 0
  buffer_load_dwordx4 v12, s[52:55], s62 offen lds
  s_add_u32 s62, s62, 16384
  s_add_u32 m0, s64, 40960
  s_nop 0
  buffer_load_dwordx4 v11, s[52:55], s62 offen lds
  s_add_u32 m0, s64, 41984
  s_nop 0
  buffer_load_dwordx4 v12, s[52:55], s62 offen lds
  s_add_u32 s62, s62, 16384
  v_bfe_u32 v26, v1, 2, 2
  v_lshrrev_b32 v27, 5, v1
  v_lshl_add_u32 v27, v27, 2, v26
  v_lshlrev_b32 v27, 7, v27
  v_bfe_u32 v28, v1, 4, 1
  v_lshlrev_b32 v28, 5, v28
  v_and_b32 v29, 3, v1
  v_lshlrev_b32 v29, 3, v29
  v_add3_u32 v27, v27, v28, v29
  v_add_u32 v27, s64, v27
  v_bfe_u32 v28, v1, 3, 1
  v_lshlrev_b32 v28, 6, v28
  v_add_u32 v8, v27, v28
  v_xor_b32 v28, 64, v28
  v_add_u32 v9, v27, v28
  v_add_u32 v4, 0x10000, v8
  v_add_u32 v5, 0x10000, v9
  s_waitcnt vmcnt(0)
  v_readfirstlane_b32 s49, v25
  s_nop 0
  s_mul_i32 s49, s49, 0x9E3779B1
  s_add_u32 s49, s49, 0x7F4A7C15
  s_or_b32 s49, s49, 1
  s_lshl_b32 s7, s47, 4
  s_add_u32 s7, s7, s48
  s_lshl_b32 s7, s7, 2
  s_add_u32 s7, s7, s45
  s_lshl_b32 s7, s7, 7
  s_add_u32 s3, s7, 0x40000
  v_mov_b32 v26, s3
  v_mov_b32 v27, s49
  s_mov_b64 exec, 1
  global_store_dword v26, v27, s[42:43] sc1
  s_mov_b64 exec, -1
  s_lshl_b32 s3, s47, 4
  s_add_u32 s3, s3, s48
  s_lshl_b32 s3, s3, 4
  s_lshl_b32 s4, s45, 2
  s_add_u32 s3, s3, s4
  s_add_u32 s3, s3, 0x60000
  v_mov_b32 v26, s3
  v_mov_b32 v27, s49
  s_mov_b64 exec, 1
  global_store_dword v26, v27, s[42:43] sc1
  s_mov_b64 exec, -1
  ds_read_b64_tr_b16 v[88:89], v8 offset:0
  ds_read_b64_tr_b16 v[90:91], v8 offset:1024
  ds_read_b64_tr_b16 v[92:93], v9 offset:0
  ds_read_b64_tr_b16 v[94:95], v9 offset:1024
  ds_read_b64_tr_b16 v[96:97], v8 offset:49152
  ds_read_b64_tr_b16 v[98:99], v8 offset:50176
  ds_read_b64_tr_b16 v[100:101], v9 offset:49152
  ds_read_b64_tr_b16 v[102:103], v9 offset:50176
  s_waitcnt lgkmcnt(0)
  s_add_u32 m0, s64, 0
  s_nop 0
  buffer_load_dwordx4 v11, s[52:55], s62 offen lds
  s_add_u32 m0, s64, 1024
  s_nop 0
  buffer_load_dwordx4 v12, s[52:55], s62 offen lds
  s_add_u32 s62, s62, 16384
  s_add_u32 m0, s64, 49152
  s_nop 0
  buffer_load_dwordx4 v11, s[52:55], s62 offen lds
  s_add_u32 m0, s64, 50176
  s_nop 0
  buffer_load_dwordx4 v12, s[52:55], s62 offen lds
  s_add_u32 s62, s62, 16384
  ds_read_b64_tr_b16 v[104:105], v8 offset:57344
  ds_read_b64_tr_b16 v[106:107], v8 offset:58368
  ds_read_b64_tr_b16 v[108:109], v9 offset:57344
  ds_read_b64_tr_b16 v[110:111], v9 offset:58368
  ds_read_b64_tr_b16 v[112:113], v8 offset:8192
  ds_read_b64_tr_b16 v[114:115], v8 offset:9216
  ds_read_b64_tr_b16 v[116:117], v9 offset:8192
  ds_read_b64_tr_b16 v[118:119], v9 offset:9216
  s_waitcnt lgkmcnt(0)
  s_add_u32 m0, s64, 57344
  s_nop 0
  buffer_load_dwordx4 v11, s[52:55], s62 offen lds
  s_add_u32 m0, s64, 58368
  s_nop 0
  buffer_load_dwordx4 v12, s[52:55], s62 offen lds
  s_add_u32 s62, s62, 16384
  s_add_u32 m0, s64, 8192
  s_nop 0
  buffer_load_dwordx4 v11, s[52:55], s62 offen lds
  s_add_u32 m0, s64, 9216
  s_nop 0
  buffer_load_dwordx4 v12, s[52:55], s62 offen lds
  s_add_u32 s62, s62, 16384
  ds_read_b64_tr_b16 v[120:121], v8 offset:16384
  ds_read_b64_tr_b16 v[122:123], v8 offset:17408
  ds_read_b64_tr_b16 v[124:125], v9 offset:16384
  ds_read_b64_tr_b16 v[126:127], v9 offset:17408
  ds_read_b64_tr_b16 v[128:129], v8 offset:24576
  ds_read_b64_tr_b16 v[130:131], v8 offset:25600
  ds_read_b64_tr_b16 v[132:133], v9 offset:24576
  ds_read_b64_tr_b16 v[134:135], v9 offset:25600
  s_waitcnt lgkmcnt(0)
  s_add_u32 m0, s64, 16384
  s_nop 0
  buffer_load_dwordx4 v11, s[52:55], s62 offen lds
  s_add_u32 m0, s64, 17408
  s_nop 0
  buffer_load_dwordx4 v12, s[52:55], s62 offen lds
  s_add_u32 s62, s62, 16384
  s_add_u32 m0, s64, 24576
  s_nop 0
  buffer_load_dwordx4 v11, s[52:55], s62 offen lds
  s_add_u32 m0, s64, 25600
  s_nop 0
  buffer_load_dwordx4 v12, s[52:55], s62 offen lds
  s_add_u32 s62, s62, 16384
  ds_read_b64_tr_b16 v[32:33], v4 offset:0
  ds_read_b64_tr_b16 v[34:35], v4 offset:1024
  ds_read_b64_tr_b16 v[36:37], v5 offset:0
  ds_read_b64_tr_b16 v[38:39], v5 offset:1024
  ds_read_b64_tr_b16 v[40:41], v4 offset:8192
  ds_read_b64_tr_b16 v[42:43], v4 offset:9216
  ds_read_b64_tr_b16 v[44:45], v5 offset:8192
  ds_read_b64_tr_b16 v[46:47], v5 offset:9216
  s_waitcnt lgkmcnt(0)
  s_add_u32 m0, s64, 65536
  s_nop 0
  buffer_load_dwordx4 v11, s[52:55], s62 offen lds
  s_add_u32 m0, s64, 66560
  s_nop 0
  buffer_load_dwordx4 v12, s[52:55], s62 offen lds
  s_add_u32 s62, s62, 16384
  s_add_u32 m0, s64, 73728
  s_nop 0
  buffer_load_dwordx4 v11, s[52:55], s62 offen lds
  s_add_u32 m0, s64, 74752
  s_nop 0
  buffer_load_dwordx4 v12, s[52:55], s62 offen lds
  s_add_u32 s62, s62, 16384
  ds_read_b64_tr_b16 v[48:49], v8 offset:32768
  ds_read_b64_tr_b16 v[50:51], v8 offset:33792
  ds_read_b64_tr_b16 v[52:53], v9 offset:32768
  ds_read_b64_tr_b16 v[54:55], v9 offset:33792
  ds_read_b64_tr_b16 v[140:141], v8 offset:40960
  ds_read_b64_tr_b16 v[142:143], v8 offset:41984
  ds_read_b64_tr_b16 v[144:145], v9 offset:40960
  ds_read_b64_tr_b16 v[146:147], v9 offset:41984
  s_waitcnt lgkmcnt(0)
  s_add_u32 m0, s64, 32768
  s_nop 0
  buffer_load_dwordx4 v11, s[52:55], s62 offen lds
  s_add_u32 m0, s64, 33792
  s_nop 0
  buffer_load_dwordx4 v12, s[52:55], s62 offen lds
  s_add_u32 s62, s62, 16384
  s_add_u32 m0, s64, 40960
  s_nop 0
  buffer_load_dwordx4 v11, s[52:55], s62 offen lds
  s_add_u32 m0, s64, 41984
  s_nop 0
  buffer_load_dwordx4 v12, s[52:55], s62 offen lds
  s_add_u32 s62, s62, 16384
  s_branch L_g2i
L_ssm:
  s_sub_u32 s46, s2, 256
  s_setprio 1
  s_and_b32 s3, s46, 7
  s_lshr_b32 s4, s46, 3
  s_lshl_b32 s3, s3, 5
  s_add_u32 s46, s3, s4
  s_mov_b32 s47, s46
  s_lshl_b32 s3, s47, 13
  s_lshl_b32 s4, s45, 11
  s_add_u32 s3, s3, s4
  v_lshlrev_b32 v3, 4, v1
  v_add_u32 v3, s3, v3
  s_lshr_b32 s60, s45, 1
  s_and_b32 s61, s45, 1
  s_lshl_b32 s4, s46, 1
  s_add_u32 s4, s4, s60
  s_lshl_b32 s4, s4, 8
  s_lshl_b32 s5, s61, 7
  s_add_u32 s4, s4, s5
  v_lshlrev_b32 v12, 1, v1
  v_add_u32 v12, s4, v12
  v_mov_b32 v13, 0
  s_lshl_b32 s3, s46, 2
  s_waitcnt lgkmcnt(0)
  global_load_dwordx4 v[4:7], v3, s[16:17]
  global_load_dwordx4 v[8:11], v3, s[16:17] offset:1024
  global_load_dword v214, v13, s[42:43] sc1
  global_load_ushort v210, v12, s[18:19]
  global_load_ushort v211, v12, s[20:21]
  global_load_ushort v212, v12, s[22:23]
  global_load_ushort v213, v12, s[24:25]
  s_load_dword s62, s[26:27], s3
  s_load_dword s63, s[28:29], s3
  s_lshl_b32 s5, s60, 6
  v_add_u32 v185, s5, v1
  v_lshrrev_b32 v184, 1, v185
  v_lshlrev_b32 v184, 13, v184
  v_and_b32 v185, 1, v185
  v_lshlrev_b32 v185, 4, v185
  s_lshl_b32 s4, s46, 5
  s_add_u32 s4, s4, 0x100000
  v_add3_u32 v184, v184, v185, s4
  v_add_u32 v185, 0x80000, v184
  v_add_u32 v186, 0x100000, v184
  v_add_u32 v187, 0x180000, v184
  s_lshr_b32 s4, s46, 6
  s_lshl_b32 s4, s4, 8
  s_lshl_b32 s5, s60, 5
  s_add_u32 s4, s4, s5
  v_and_b32 v239, 31, v1
  v_lshrrev_b32 v238, 5, v1
  v_lshl_add_u32 v239, v238, 6, v239
  v_add_u32 v239, s4, v239
  v_lshlrev_b32 v239, 4, v239
  v_add_u32 v239, 0x30000, v239
  s_waitcnt vmcnt(5)
  v_dot2_f32_bf16 v12, v4, s44, 0
  v_dot2_f32_bf16 v13, v4, v4, 0
  v_dot2_f32_bf16 v14, v8, s44, 0
  v_dot2_f32_bf16 v15, v8, v8, 0
  v_dot2_f32_bf16 v12, v5, s44, v12
  v_dot2_f32_bf16 v13, v5, v5, v13
  v_dot2_f32_bf16 v14, v9, s44, v14
  v_dot2_f32_bf16 v15, v9, v9, v15
  v_dot2_f32_bf16 v12, v6, s44, v12
  v_dot2_f32_bf16 v13, v6, v6, v13
  v_dot2_f32_bf16 v14, v10, s44, v14
  v_dot2_f32_bf16 v15, v10, v10, v15
  v_dot2_f32_bf16 v12, v7, s44, v12
  v_dot2_f32_bf16 v13, v7, v7, v13
  v_dot2_f32_bf16 v14, v11, s44, v14
  v_dot2_f32_bf16 v15, v11, v11, v15
  v_lshlrev_b32 v20, 16, v4
  v_and_b32 v21, 0xffff0000, v4
  v_lshlrev_b32 v22, 16, v5
  v_and_b32 v23, 0xffff0000, v5
  v_lshlrev_b32 v24, 16, v6
  v_and_b32 v25, 0xffff0000, v6
  v_lshlrev_b32 v26, 16, v7
  v_and_b32 v27, 0xffff0000, v7
  v_lshlrev_b32 v28, 16, v8
  v_and_b32 v29, 0xffff0000, v8
  v_lshlrev_b32 v30, 16, v9
  v_and_b32 v31, 0xffff0000, v9
  v_lshlrev_b32 v32, 16, v10
  v_and_b32 v33, 0xffff0000, v10
  v_lshlrev_b32 v34, 16, v11
  v_and_b32 v35, 0xffff0000, v11
  v_add_f32_dpp v12, v12, v12 quad_perm:[1,0,3,2] row_mask:0xf bank_mask:0xf
  v_add_f32_dpp v13, v13, v13 quad_perm:[1,0,3,2] row_mask:0xf bank_mask:0xf
  v_add_f32_dpp v14, v14, v14 quad_perm:[1,0,3,2] row_mask:0xf bank_mask:0xf
  v_add_f32_dpp v15, v15, v15 quad_perm:[1,0,3,2] row_mask:0xf bank_mask:0xf
  v_add_f32_dpp v12, v12, v12 quad_perm:[2,3,0,1] row_mask:0xf bank_mask:0xf
  v_add_f32_dpp v13, v13, v13 quad_perm:[2,3,0,1] row_mask:0xf bank_mask:0xf
  v_add_f32_dpp v14, v14, v14 quad_perm:[2,3,0,1] row_mask:0xf bank_mask:0xf
  v_add_f32_dpp v15, v15, v15 quad_perm:[2,3,0,1] row_mask:0xf bank_mask:0xf
  v_add_f32_dpp v12, v12, v12 row_half_mirror row_mask:0xf bank_mask:0xf
  v_add_f32_dpp v13, v13, v13 row_half_mirror row_mask:0xf bank_mask:0xf
  v_add_f32_dpp v14, v14, v14 row_half_mirror row_mask:0xf bank_mask:0xf
  v_add_f32_dpp v15, v15, v15 row_half_mirror row_mask:0xf bank_mask:0xf
  v_add_f32_dpp v12, v12, v12 row_mirror row_mask:0xf bank_mask:0xf
  v_add_f32_dpp v13, v13, v13 row_mirror row_mask:0xf bank_mask:0xf
  v_add_f32_dpp v14, v14, v14 row_mirror row_mask:0xf bank_mask:0xf
  v_add_f32_dpp v15, v15, v15 row_mirror row_mask:0xf bank_mask:0xf
  v_mov_b32 v16, v12
  v_mov_b32 v17, v13
  v_mov_b32 v18, v14
  v_mov_b32 v19, v15
  v_permlane16_swap_b32 v12, v16
  v_permlane16_swap_b32 v13, v17
  v_permlane16_swap_b32 v14, v18
  v_permlane16_swap_b32 v15, v19
  v_add_f32 v12, v12, v16
  v_add_f32 v13, v13, v17
  v_add_f32 v14, v14, v18
  v_add_f32 v15, v15, v19
  v_mov_b32 v16, v12
  v_mov_b32 v17, v13
  v_mov_b32 v18, v14
  v_mov_b32 v19, v15
  v_permlane32_swap_b32 v12, v16
  v_permlane32_swap_b32 v13, v17
  v_permlane32_swap_b32 v14, v18
  v_permlane32_swap_b32 v15, v19
  v_add_f32 v12, v12, v16
  v_add_f32 v13, v13, v17
  v_add_f32 v14, v14, v18
  v_add_f32 v15, v15, v19
  v_mul_f32 v12, 0x3b000000, v12
  v_mul_f32 v13, 0x3b000000, v13
  v_mul_f32 v14, 0x3b000000, v14
  v_mul_f32 v15, 0x3b000000, v15
  v_fma_f32 v13, -v12, v12, v13
  v_cvt_pk_bf16_f32 v36, v12, v13
  v_fma_f32 v15, -v14, v14, v15
  v_cvt_pk_bf16_f32 v37, v14, v15
  v_and_b32 v13, 0xffff0000, v36
  v_lshlrev_b32 v36, 16, v36
  v_add_f32 v13, 0x3727c5ac, v13
  v_and_b32 v15, 0xffff0000, v37
  v_lshlrev_b32 v37, 16, v37
  v_add_f32 v15, 0x3727c5ac, v15
  v_cvt_pk_bf16_f32 v13, v13, v13
  v_cvt_pk_bf16_f32 v15, v15, v15
  v_lshlrev_b32 v13, 16, v13
  v_lshlrev_b32 v15, 16, v15
  v_sqrt_f32 v13, v13
  v_sqrt_f32 v15, v15
  v_cvt_pk_bf16_f32 v13, v13, v13
  v_cvt_pk_bf16_f32 v15, v15, v15
  v_lshlrev_b32 v13, 16, v13
  v_lshlrev_b32 v15, 16, v15
  v_rcp_f32 v38, v13
  v_lshrrev_b32 v232, 16, v36
  v_or_b32 v232, v232, v13
  v_rcp_f32 v39, v15
  v_lshrrev_b32 v234, 16, v37
  v_or_b32 v234, v234, v15
  s_waitcnt vmcnt(4)
  v_readfirstlane_b32 s49, v214
  s_nop 0
  s_mul_i32 s49, s49, 0x9E3779B1
  s_add_u32 s49, s49, 0x7F4A7C15
  s_or_b32 s49, s49, 1
  s_lshl_b32 s4, s47, 6
  s_lshl_b32 s5, s45, 4
  s_add_u32 s4, s4, s5
  s_add_u32 s4, s4, 0x8000
  v_mov_b32 v237, s4
  v_xor_b32 v233, s49, v232
  v_xor_b32 v235, s49, v234
  s_mov_b64 exec, 1
  global_store_dwordx4 v237, v[232:235], s[42:43] sc1
  s_mov_b64 exec, -1
  v_sub_f32 v20, v20, v36
  v_sub_f32 v21, v21, v36
  v_sub_f32 v22, v22, v36
  v_sub_f32 v23, v23, v36
  v_sub_f32 v24, v24, v36
  v_sub_f32 v25, v25, v36
  v_sub_f32 v26, v26, v36
  v_sub_f32 v27, v27, v36
  v_cvt_pk_bf16_f32 v4, v20, v21
  v_cvt_pk_bf16_f32 v5, v22, v23
  v_cvt_pk_bf16_f32 v6, v24, v25
  v_cvt_pk_bf16_f32 v7, v26, v27
  v_lshlrev_b32 v20, 16, v4
  v_and_b32 v21, 0xffff0000, v4
  v_lshlrev_b32 v22, 16, v5
  v_and_b32 v23, 0xffff0000, v5
  v_lshlrev_b32 v24, 16, v6
  v_and_b32 v25, 0xffff0000, v6
  v_lshlrev_b32 v26, 16, v7
  v_and_b32 v27, 0xffff0000, v7
  v_mul_f32 v20, v20, v38
  v_mul_f32 v21, v21, v38
  v_mul_f32 v22, v22, v38
  v_mul_f32 v23, v23, v38
  v_mul_f32 v24, v24, v38
  v_mul_f32 v25, v25, v38
  v_mul_f32 v26, v26, v38
  v_mul_f32 v27, v27, v38
  v_cvt_pk_bf16_f32 v4, v20, v21
  v_cvt_pk_bf16_f32 v5, v22, v23
  v_cvt_pk_bf16_f32 v6, v24, v25
  v_cvt_pk_bf16_f32 v7, v26, v27
  v_sub_f32 v28, v28, v37
  v_sub_f32 v29, v29, v37
  v_sub_f32 v30, v30, v37
  v_sub_f32 v31, v31, v37
  v_sub_f32 v32, v32, v37
  v_sub_f32 v33, v33, v37
  v_sub_f32 v34, v34, v37
  v_sub_f32 v35, v35, v37
  v_cvt_pk_bf16_f32 v8, v28, v29
  v_cvt_pk_bf16_f32 v9, v30, v31
  v_cvt_pk_bf16_f32 v10, v32, v33
  v_cvt_pk_bf16_f32 v11, v34, v35
  v_lshlrev_b32 v28, 16, v8
  v_and_b32 v29, 0xffff0000, v8
  v_lshlrev_b32 v30, 16, v9
  v_and_b32 v31, 0xffff0000, v9
  v_lshlrev_b32 v32, 16, v10
  v_and_b32 v33, 0xffff0000, v10
  v_lshlrev_b32 v34, 16, v11
  v_and_b32 v35, 0xffff0000, v11
  v_mul_f32 v28, v28, v39
  v_mul_f32 v29, v29, v39
  v_mul_f32 v30, v30, v39
  v_mul_f32 v31, v31, v39
  v_mul_f32 v32, v32, v39
  v_mul_f32 v33, v33, v39
  v_mul_f32 v34, v34, v39
  v_mul_f32 v35, v35, v39
  v_cvt_pk_bf16_f32 v8, v28, v29
  v_cvt_pk_bf16_f32 v9, v30, v31
  v_cvt_pk_bf16_f32 v10, v32, v33
  v_cvt_pk_bf16_f32 v11, v34, v35
  s_mul_i32 s4, s45, 2176
  s_add_u32 s4, s4, 67584
  v_lshlrev_b32 v3, 4, v1
  v_add_u32 v3, s4, v3
  ds_write_b128 v3, v[4:7]
  ds_write_b128 v3, v[8:11] offset:1088
  v_bfe_u32 v4, v1, 2, 2
  v_mul_u32_u24 v4, 1088, v4
  v_lshrrev_b32 v5, 4, v1
  v_lshlrev_b32 v5, 5, v5
  v_and_b32 v6, 3, v1
  v_lshlrev_b32 v6, 3, v6
  v_add3_u32 v4, v4, v5, v6
  s_lshl_b32 s4, s45, 8
  s_add_u32 s4, s4, 67584
  v_add_u32 v4, s4, v4
  s_lshl_b32 s4, s47, 13
  s_lshl_b32 s5, s45, 11
  s_add_u32 s4, s4, s5
  s_add_u32 s4, s4, 0x100000
  v_lshlrev_b32 v5, 4, v1
  v_add_u32 v236, s4, v5
  s_waitcnt lgkmcnt(0)
  s_barrier
  ds_read_b64_tr_b16 v[224:225], v4
  ds_read_b64_tr_b16 v[226:227], v4 offset:4352
  ds_read_b64_tr_b16 v[228:229], v4 offset:128
  ds_read_b64_tr_b16 v[230:231], v4 offset:4480
  s_waitcnt lgkmcnt(0)
  global_store_dwordx4 v236, v[224:227], s[42:43] sc1
  global_store_dwordx4 v236, v[228:231], s[42:43] offset:1024 sc1
  s_setprio 1
  s_waitcnt vmcnt(3)
  s_lshl_b32 s5, s60, 4
  s_lshr_b32 s62, s62, s5
  s_lshl_b32 s62, s62, 16
  s_lshr_b32 s63, s63, s5
  s_lshl_b32 s63, s63, 16
  v_mov_b32 v8, s62
  v_mul_f32 v9, 0x3fb8aa3b, v8
  v_mov_b32 v10, 0x3fb8aa3b
  v_fma_f32 v10, v8, v10, -v9
  v_fmac_f32 v10, 0x32a57060, v8
  v_exp_f32 v9, v9
  v_mul_f32 v10, 0x3f317218, v10
  v_fma_f32 v8, v9, v10, v9
  v_cvt_pk_bf16_f32 v8, v8, v8
  v_lshlrev_b32 v8, 16, v8
  v_lshlrev_b32 v4, 16, v210
  v_lshlrev_b32 v5, 16, v211
  v_lshlrev_b32 v6, 16, v212
  v_lshlrev_b32 v7, 16, v213
  v_mul_f32 v9, 0x3fb8aa3b, v4
  v_mov_b32 v10, 0x3fb8aa3b
  v_fma_f32 v10, v4, v10, -v9
  v_fmac_f32 v10, 0x32a57060, v4
  v_exp_f32 v9, v9
  v_mul_f32 v10, 0x3f317218, v10
  v_fma_f32 v4, v9, v10, v9
  v_cvt_pk_bf16_f32 v4, v4, v4
  v_lshlrev_b32 v4, 16, v4
  v_mul_f32 v14, v4, v8
  v_mul_f32 v14, 0xbfb8aa3b, v14
  v_mul_f32 v15, v5, v8
  v_mul_f32 v15, 0x3e22f983, v15
  v_add_f32 v8, v8, v8
  v_mul_f32 v12, v6, v8
  v_mul_f32 v13, v7, v8
  v_exp_f32 v9, v14
  v_cos_f32 v16, v15
  v_sin_f32 v17, v15
  v_mul_f32 v16, v16, v9
  v_mul_f32 v17, v17, v9
  v_mul_f32 v10, 0x41000000, v14
  v_mul_f32 v11, 0x41000000, v15
  v_exp_f32 v9, v10
  v_cos_f32 v18, v11
  v_sin_f32 v19, v11
  v_mul_f32 v18, v18, v9
  v_mul_f32 v19, v19, v9
  v_mul_f32 v10, 0x43800000, v14
  v_mul_f32 v11, 0x43800000, v15
  v_exp_f32 v9, v10
  v_cos_f32 v20, v11
  v_sin_f32 v21, v11
  v_mul_f32 v20, v20, v9
  v_mul_f32 v21, v21, v9
  v_mul_f32 v22, v16, v16
  v_mul_f32 v23, v17, v16
  v_fma_f32 v22, -v17, v17, v22
  v_fma_f32 v23, v16, v17, v23
  v_mul_f32 v26, v18, v18
  v_mul_f32 v27, v19, v18
  v_fma_f32 v26, -v19, v19, v26
  v_fma_f32 v27, v18, v19, v27
  v_mul_f32 v24, v22, v22
  v_mul_f32 v25, v23, v22
  v_fma_f32 v24, -v23, v23, v24
  v_fma_f32 v25, v22, v23, v25
  v_mov_b32 v162, 1.0
  v_mov_b32 v163, 0
  v_mul_f32 v100, v162, v26
  v_mul_f32 v101, v163, v26
  v_fma_f32 v100, -v163, v27, v100
  v_fma_f32 v101, v162, v27, v101
  v_mul_f32 v44, v12, v16
  v_mul_f32 v45, v13, v16
  v_fma_f32 v44, -v13, v17, v44
  v_fma_f32 v45, v12, v17, v45
  v_mul_f32 v102, v18, v26
  v_mul_f32 v103, v19, v26
  v_fma_f32 v102, -v19, v27, v102
  v_fma_f32 v103, v18, v27, v103
  v_mul_f32 v46, v12, v20
  v_mul_f32 v47, v13, v20
  v_fma_f32 v46, -v13, v21, v46
  v_fma_f32 v47, v12, v21, v47
  v_mul_f32 v104, v100, v26
  v_mul_f32 v105, v101, v26
  v_fma_f32 v104, -v101, v27, v104
  v_fma_f32 v105, v100, v27, v105
  v_mul_f32 v48, v44, v16
  v_mul_f32 v49, v45, v16
  v_fma_f32 v48, -v45, v17, v48
  v_fma_f32 v49, v44, v17, v49
  v_cvt_pk_bf16_f32 v162, v162, v163
  v_mul_f32 v106, v102, v26
  v_mul_f32 v107, v103, v26
  v_fma_f32 v106, -v103, v27, v106
  v_fma_f32 v107, v102, v27, v107
  v_mul_f32 v50, v46, v20
  v_mul_f32 v51, v47, v20
  v_fma_f32 v50, -v47, v21, v50
  v_fma_f32 v51, v46, v21, v51
  v_cvt_pk_bf16_f32 v160, v18, v19
  v_mul_f32 v108, v104, v26
  v_mul_f32 v109, v105, v26
  v_fma_f32 v108, -v105, v27, v108
  v_fma_f32 v109, v104, v27, v109
  v_mul_f32 v52, v48, v16
  v_mul_f32 v53, v49, v16
  v_fma_f32 v52, -v49, v17, v52
  v_fma_f32 v53, v48, v17, v53
  v_cvt_pk_bf16_f32 v100, v100, v101
  v_mul_f32 v110, v106, v26
  v_mul_f32 v111, v107, v26
  v_fma_f32 v110, -v107, v27, v110
  v_fma_f32 v111, v106, v27, v111
  v_mul_f32 v54, v46, v22
  v_mul_f32 v55, v47, v22
  v_fma_f32 v54, -v47, v23, v54
  v_fma_f32 v55, v46, v23, v55
  v_cvt_pk_bf16_f32 v102, v102, v103
  v_mul_f32 v112, v108, v26
  v_mul_f32 v113, v109, v26
  v_fma_f32 v112, -v109, v27, v112
  v_fma_f32 v113, v108, v27, v113
  v_mul_f32 v56, v52, v16
  v_mul_f32 v57, v53, v16
  v_fma_f32 v56, -v53, v17, v56
  v_fma_f32 v57, v52, v17, v57
  v_cvt_pk_bf16_f32 v104, v104, v105
  v_mul_f32 v114, v110, v26
  v_mul_f32 v115, v111, v26
  v_fma_f32 v114, -v111, v27, v114
  v_fma_f32 v115, v110, v27, v115
  v_mul_f32 v58, v50, v20
  v_mul_f32 v59, v51, v20
  v_fma_f32 v58, -v51, v21, v58
  v_fma_f32 v59, v50, v21, v59
  v_cvt_pk_bf16_f32 v106, v106, v107
  v_mul_f32 v116, v112, v26
  v_mul_f32 v117, v113, v26
  v_fma_f32 v116, -v113, v27, v116
  v_fma_f32 v117, v112, v27, v117
  v_mul_f32 v60, v56, v16
  v_mul_f32 v61, v57, v16
  v_fma_f32 v60, -v57, v17, v60
  v_fma_f32 v61, v56, v17, v61
  v_cvt_pk_bf16_f32 v108, v108, v109
  v_mul_f32 v118, v114, v26
  v_mul_f32 v119, v115, v26
  v_fma_f32 v118, -v115, v27, v118
  v_fma_f32 v119, v114, v27, v119
  v_mul_f32 v62, v46, v24
  v_mul_f32 v63, v47, v24
  v_fma_f32 v62, -v47, v25, v62
  v_fma_f32 v63, v46, v25, v63
  v_cvt_pk_bf16_f32 v110, v110, v111
  v_mul_f32 v120, v116, v26
  v_mul_f32 v121, v117, v26
  v_fma_f32 v120, -v117, v27, v120
  v_fma_f32 v121, v116, v27, v121
  v_mul_f32 v64, v60, v16
  v_mul_f32 v65, v61, v16
  v_fma_f32 v64, -v61, v17, v64
  v_fma_f32 v65, v60, v17, v65
  v_cvt_pk_bf16_f32 v112, v112, v113
  v_mul_f32 v122, v118, v26
  v_mul_f32 v123, v119, v26
  v_fma_f32 v122, -v119, v27, v122
  v_fma_f32 v123, v118, v27, v123
  v_mul_f32 v66, v58, v20
  v_mul_f32 v67, v59, v20
  v_fma_f32 v66, -v59, v21, v66
  v_fma_f32 v67, v58, v21, v67
  v_cvt_pk_bf16_f32 v114, v114, v115
  v_mul_f32 v124, v120, v26
  v_mul_f32 v125, v121, v26
  v_fma_f32 v124, -v121, v27, v124
  v_fma_f32 v125, v120, v27, v125
  v_mul_f32 v68, v64, v16
  v_mul_f32 v69, v65, v16
  v_fma_f32 v68, -v65, v17, v68
  v_fma_f32 v69, v64, v17, v69
  v_cvt_pk_bf16_f32 v116, v116, v117
  v_mul_f32 v126, v122, v26
  v_mul_f32 v127, v123, v26
  v_fma_f32 v126, -v123, v27, v126
  v_fma_f32 v127, v122, v27, v127
  v_mul_f32 v70, v54, v24
  v_mul_f32 v71, v55, v24
  v_fma_f32 v70, -v55, v25, v70
  v_fma_f32 v71, v54, v25, v71
  v_cvt_pk_bf16_f32 v118, v118, v119
  v_mul_f32 v128, v124, v26
  v_mul_f32 v129, v125, v26
  v_fma_f32 v128, -v125, v27, v128
  v_fma_f32 v129, v124, v27, v129
  v_mul_f32 v72, v46, v18
  v_mul_f32 v73, v47, v18
  v_fma_f32 v72, -v47, v19, v72
  v_fma_f32 v73, v46, v19, v73
  v_cvt_pk_bf16_f32 v120, v120, v121
  v_mul_f32 v130, v126, v26
  v_mul_f32 v131, v127, v26
  v_fma_f32 v130, -v127, v27, v130
  v_fma_f32 v131, v126, v27, v131
  v_mul_f32 v74, v66, v20
  v_mul_f32 v75, v67, v20
  v_fma_f32 v74, -v67, v21, v74
  v_fma_f32 v75, v66, v21, v75
  v_cvt_pk_bf16_f32 v122, v122, v123
  v_mul_f32 v132, v128, v26
  v_mul_f32 v133, v129, v26
  v_fma_f32 v132, -v129, v27, v132
  v_fma_f32 v133, v128, v27, v133
  v_mul_f32 v76, v50, v24
  v_mul_f32 v77, v51, v24
  v_fma_f32 v76, -v51, v25, v76
  v_fma_f32 v77, v50, v25, v77
  v_cvt_pk_bf16_f32 v124, v124, v125
  v_mul_f32 v134, v130, v26
  v_mul_f32 v135, v131, v26
  v_fma_f32 v134, -v131, v27, v134
  v_fma_f32 v135, v130, v27, v135
  v_mul_f32 v78, v50, v18
  v_mul_f32 v79, v51, v18
  v_fma_f32 v78, -v51, v19, v78
  v_fma_f32 v79, v50, v19, v79
  v_cvt_pk_bf16_f32 v126, v126, v127
  v_mul_f32 v136, v132, v26
  v_mul_f32 v137, v133, v26
  v_fma_f32 v136, -v133, v27, v136
  v_fma_f32 v137, v132, v27, v137
  v_mul_f32 v80, v74, v20
  v_mul_f32 v81, v75, v20
  v_fma_f32 v80, -v75, v21, v80
  v_fma_f32 v81, v74, v21, v81
  v_cvt_pk_bf16_f32 v128, v128, v129
  v_mul_f32 v138, v134, v26
  v_mul_f32 v139, v135, v26
  v_fma_f32 v138, -v135, v27, v138
  v_fma_f32 v139, v134, v27, v139
  v_mul_f32 v82, v58, v24
  v_mul_f32 v83, v59, v24
  v_fma_f32 v82, -v59, v25, v82
  v_fma_f32 v83, v58, v25, v83
  v_cvt_pk_bf16_f32 v130, v130, v131
  s_waitcnt vmcnt(0)
  s_lshl_b32 s7, s45, 8
  s_add_u32 s7, s7, s47
  s_lshl_b32 s7, s7, 4
  s_add_u32 s3, s7, 0x30000
  v_mov_b32 v242, s3
  v_mov_b32 v243, s49
  s_mov_b64 exec, 1
  global_store_dword v242, v243, s[42:43] sc1
  s_mov_b64 exec, -1
  v_mul_f32 v140, v136, v26
  v_mul_f32 v141, v137, v26
  v_fma_f32 v140, -v137, v27, v140
  v_fma_f32 v141, v136, v27, v141
  v_mul_f32 v84, v58, v18
  v_mul_f32 v85, v59, v18
  v_fma_f32 v84, -v59, v19, v84
  v_fma_f32 v85, v58, v19, v85
  v_cvt_pk_bf16_f32 v132, v132, v133
  v_mul_f32 v142, v138, v26
  v_mul_f32 v143, v139, v26
  v_fma_f32 v142, -v139, v27, v142
  v_fma_f32 v143, v138, v27, v143
  v_mul_f32 v86, v80, v20
  v_mul_f32 v87, v81, v20
  v_fma_f32 v86, -v81, v21, v86
  v_fma_f32 v87, v80, v21, v87
  v_cvt_pk_bf16_f32 v134, v134, v135
  v_mul_f32 v144, v140, v26
  v_mul_f32 v145, v141, v26
  v_fma_f32 v144, -v141, v27, v144
  v_fma_f32 v145, v140, v27, v145
  v_mul_f32 v88, v66, v18
  v_mul_f32 v89, v67, v18
  v_fma_f32 v88, -v67, v19, v88
  v_fma_f32 v89, v66, v19, v89
  v_cvt_pk_bf16_f32 v136, v136, v137
  v_mul_f32 v146, v142, v26
  v_mul_f32 v147, v143, v26
  v_fma_f32 v146, -v143, v27, v146
  v_fma_f32 v147, v142, v27, v147
  v_mul_f32 v90, v74, v18
  v_mul_f32 v91, v75, v18
  v_fma_f32 v90, -v75, v19, v90
  v_fma_f32 v91, v74, v19, v91
  v_cvt_pk_bf16_f32 v138, v138, v139
  v_mul_f32 v148, v144, v26
  v_mul_f32 v149, v145, v26
  v_fma_f32 v148, -v145, v27, v148
  v_fma_f32 v149, v144, v27, v149
  v_mul_f32 v92, v80, v18
  v_mul_f32 v93, v81, v18
  v_fma_f32 v92, -v81, v19, v92
  v_fma_f32 v93, v80, v19, v93
  v_cvt_pk_bf16_f32 v140, v140, v141
  v_mul_f32 v150, v146, v26
  v_mul_f32 v151, v147, v26
  v_fma_f32 v150, -v147, v27, v150
  v_fma_f32 v151, v146, v27, v151
  v_mul_f32 v94, v86, v18
  v_mul_f32 v95, v87, v18
  v_fma_f32 v94, -v87, v19, v94
  v_fma_f32 v95, v86, v19, v95
  v_cvt_pk_bf16_f32 v142, v142, v143
  v_mul_f32 v152, v148, v26
  v_mul_f32 v153, v149, v26
  v_fma_f32 v152, -v149, v27, v152
  v_fma_f32 v153, v148, v27, v153
  v_cvt_pk_bf16_f32 v144, v144, v145
  v_mul_f32 v154, v150, v26
  v_mul_f32 v155, v151, v26
  v_fma_f32 v154, -v151, v27, v154
  v_fma_f32 v155, v150, v27, v155
  v_cvt_pk_bf16_f32 v146, v146, v147
  v_mul_f32 v156, v152, v26
  v_mul_f32 v157, v153, v26
  v_fma_f32 v156, -v153, v27, v156
  v_fma_f32 v157, v152, v27, v157
  v_cvt_pk_bf16_f32 v148, v148, v149
  v_mul_f32 v158, v154, v26
  v_mul_f32 v159, v155, v26
  v_fma_f32 v158, -v155, v27, v158
  v_fma_f32 v159, v154, v27, v159
  v_cvt_pk_bf16_f32 v150, v150, v151
  v_cvt_pk_bf16_f32 v152, v152, v153
  v_cvt_pk_bf16_f32 v154, v154, v155
  v_cvt_pk_bf16_f32 v156, v156, v157
  v_cvt_pk_bf16_f32 v158, v158, v159
  s_nop 1
  s_mov_b32 vcc_lo, 0xff00ff
  s_mov_b32 vcc_hi, 0xff00ff
  v_cndmask_b32_dpp v163, v112, v162, vcc row_shr:8 row_mask:0xf bank_mask:0xf bound_ctrl:0
  v_cndmask_b32_dpp v161, v114, v160, vcc row_shr:8 row_mask:0xf bank_mask:0xf bound_ctrl:0
  v_cndmask_b32_dpp v101, v116, v100, vcc row_shr:8 row_mask:0xf bank_mask:0xf bound_ctrl:0
  v_cndmask_b32_dpp v103, v118, v102, vcc row_shr:8 row_mask:0xf bank_mask:0xf bound_ctrl:0
  v_cndmask_b32_dpp v105, v120, v104, vcc row_shr:8 row_mask:0xf bank_mask:0xf bound_ctrl:0
  v_cndmask_b32_dpp v107, v122, v106, vcc row_shr:8 row_mask:0xf bank_mask:0xf bound_ctrl:0
  v_cndmask_b32_dpp v109, v124, v108, vcc row_shr:8 row_mask:0xf bank_mask:0xf bound_ctrl:0
  v_cndmask_b32_dpp v111, v126, v110, vcc row_shr:8 row_mask:0xf bank_mask:0xf bound_ctrl:0
  v_cndmask_b32_dpp v129, v144, v128, vcc row_shr:8 row_mask:0xf bank_mask:0xf bound_ctrl:0
  v_cndmask_b32_dpp v131, v146, v130, vcc row_shr:8 row_mask:0xf bank_mask:0xf bound_ctrl:0
  v_cndmask_b32_dpp v133, v148, v132, vcc row_shr:8 row_mask:0xf bank_mask:0xf bound_ctrl:0
  v_cndmask_b32_dpp v135, v150, v134, vcc row_shr:8 row_mask:0xf bank_mask:0xf bound_ctrl:0
  v_cndmask_b32_dpp v137, v152, v136, vcc row_shr:8 row_mask:0xf bank_mask:0xf bound_ctrl:0
  v_cndmask_b32_dpp v139, v154, v138, vcc row_shr:8 row_mask:0xf bank_mask:0xf bound_ctrl:0
  v_cndmask_b32_dpp v141, v156, v140, vcc row_shr:8 row_mask:0xf bank_mask:0xf bound_ctrl:0
  v_cndmask_b32_dpp v143, v158, v142, vcc row_shr:8 row_mask:0xf bank_mask:0xf bound_ctrl:0
  s_not_b64 vcc, vcc
  v_cndmask_b32_dpp v113, v162, v112, vcc row_shl:8 row_mask:0xf bank_mask:0xf bound_ctrl:0
  v_cndmask_b32_dpp v115, v160, v114, vcc row_shl:8 row_mask:0xf bank_mask:0xf bound_ctrl:0
  v_cndmask_b32_dpp v117, v100, v116, vcc row_shl:8 row_mask:0xf bank_mask:0xf bound_ctrl:0
  v_cndmask_b32_dpp v119, v102, v118, vcc row_shl:8 row_mask:0xf bank_mask:0xf bound_ctrl:0
  v_cndmask_b32_dpp v121, v104, v120, vcc row_shl:8 row_mask:0xf bank_mask:0xf bound_ctrl:0
  v_cndmask_b32_dpp v123, v106, v122, vcc row_shl:8 row_mask:0xf bank_mask:0xf bound_ctrl:0
  v_cndmask_b32_dpp v125, v108, v124, vcc row_shl:8 row_mask:0xf bank_mask:0xf bound_ctrl:0
  v_cndmask_b32_dpp v127, v110, v126, vcc row_shl:8 row_mask:0xf bank_mask:0xf bound_ctrl:0
  v_cndmask_b32_dpp v145, v128, v144, vcc row_shl:8 row_mask:0xf bank_mask:0xf bound_ctrl:0
  v_cndmask_b32_dpp v147, v130, v146, vcc row_shl:8 row_mask:0xf bank_mask:0xf bound_ctrl:0
  v_cndmask_b32_dpp v149, v132, v148, vcc row_shl:8 row_mask:0xf bank_mask:0xf bound_ctrl:0
  v_cndmask_b32_dpp v151, v134, v150, vcc row_shl:8 row_mask:0xf bank_mask:0xf bound_ctrl:0
  v_cndmask_b32_dpp v153, v136, v152, vcc row_shl:8 row_mask:0xf bank_mask:0xf bound_ctrl:0
  v_cndmask_b32_dpp v155, v138, v154, vcc row_shl:8 row_mask:0xf bank_mask:0xf bound_ctrl:0
  v_cndmask_b32_dpp v157, v140, v156, vcc row_shl:8 row_mask:0xf bank_mask:0xf bound_ctrl:0
  v_cndmask_b32_dpp v159, v142, v158, vcc row_shl:8 row_mask:0xf bank_mask:0xf bound_ctrl:0
  s_mov_b32 vcc_lo, 0xf0f0f0f
  s_mov_b32 vcc_hi, 0xf0f0f0f
  v_cndmask_b32_dpp v162, v105, v163, vcc row_shr:4 row_mask:0xf bank_mask:0xf bound_ctrl:0
  v_cndmask_b32_dpp v160, v107, v161, vcc row_shr:4 row_mask:0xf bank_mask:0xf bound_ctrl:0
  v_cndmask_b32_dpp v100, v109, v101, vcc row_shr:4 row_mask:0xf bank_mask:0xf bound_ctrl:0
  v_cndmask_b32_dpp v102, v111, v103, vcc row_shr:4 row_mask:0xf bank_mask:0xf bound_ctrl:0
  v_cndmask_b32_dpp v112, v121, v113, vcc row_shr:4 row_mask:0xf bank_mask:0xf bound_ctrl:0
  v_cndmask_b32_dpp v114, v123, v115, vcc row_shr:4 row_mask:0xf bank_mask:0xf bound_ctrl:0
  v_cndmask_b32_dpp v116, v125, v117, vcc row_shr:4 row_mask:0xf bank_mask:0xf bound_ctrl:0
  v_cndmask_b32_dpp v118, v127, v119, vcc row_shr:4 row_mask:0xf bank_mask:0xf bound_ctrl:0
  v_cndmask_b32_dpp v128, v137, v129, vcc row_shr:4 row_mask:0xf bank_mask:0xf bound_ctrl:0
  v_cndmask_b32_dpp v130, v139, v131, vcc row_shr:4 row_mask:0xf bank_mask:0xf bound_ctrl:0
  v_cndmask_b32_dpp v132, v141, v133, vcc row_shr:4 row_mask:0xf bank_mask:0xf bound_ctrl:0
  v_cndmask_b32_dpp v134, v143, v135, vcc row_shr:4 row_mask:0xf bank_mask:0xf bound_ctrl:0
  v_cndmask_b32_dpp v144, v153, v145, vcc row_shr:4 row_mask:0xf bank_mask:0xf bound_ctrl:0
  v_cndmask_b32_dpp v146, v155, v147, vcc row_shr:4 row_mask:0xf bank_mask:0xf bound_ctrl:0
  v_cndmask_b32_dpp v148, v157, v149, vcc row_shr:4 row_mask:0xf bank_mask:0xf bound_ctrl:0
  v_cndmask_b32_dpp v150, v159, v151, vcc row_shr:4 row_mask:0xf bank_mask:0xf bound_ctrl:0
  s_not_b64 vcc, vcc
  v_cndmask_b32_dpp v104, v163, v105, vcc row_shl:4 row_mask:0xf bank_mask:0xf bound_ctrl:0
  v_cndmask_b32_dpp v106, v161, v107, vcc row_shl:4 row_mask:0xf bank_mask:0xf bound_ctrl:0
  v_cndmask_b32_dpp v108, v101, v109, vcc row_shl:4 row_mask:0xf bank_mask:0xf bound_ctrl:0
  v_cndmask_b32_dpp v110, v103, v111, vcc row_shl:4 row_mask:0xf bank_mask:0xf bound_ctrl:0
  v_cndmask_b32_dpp v120, v113, v121, vcc row_shl:4 row_mask:0xf bank_mask:0xf bound_ctrl:0
  v_cndmask_b32_dpp v122, v115, v123, vcc row_shl:4 row_mask:0xf bank_mask:0xf bound_ctrl:0
  v_cndmask_b32_dpp v124, v117, v125, vcc row_shl:4 row_mask:0xf bank_mask:0xf bound_ctrl:0
  v_cndmask_b32_dpp v126, v119, v127, vcc row_shl:4 row_mask:0xf bank_mask:0xf bound_ctrl:0
  v_cndmask_b32_dpp v136, v129, v137, vcc row_shl:4 row_mask:0xf bank_mask:0xf bound_ctrl:0
  v_cndmask_b32_dpp v138, v131, v139, vcc row_shl:4 row_mask:0xf bank_mask:0xf bound_ctrl:0
  v_cndmask_b32_dpp v140, v133, v141, vcc row_shl:4 row_mask:0xf bank_mask:0xf bound_ctrl:0
  v_cndmask_b32_dpp v142, v135, v143, vcc row_shl:4 row_mask:0xf bank_mask:0xf bound_ctrl:0
  v_cndmask_b32_dpp v152, v145, v153, vcc row_shl:4 row_mask:0xf bank_mask:0xf bound_ctrl:0
  v_cndmask_b32_dpp v154, v147, v155, vcc row_shl:4 row_mask:0xf bank_mask:0xf bound_ctrl:0
  v_cndmask_b32_dpp v156, v149, v157, vcc row_shl:4 row_mask:0xf bank_mask:0xf bound_ctrl:0
  v_cndmask_b32_dpp v158, v151, v159, vcc row_shl:4 row_mask:0xf bank_mask:0xf bound_ctrl:0
  s_mov_b32 vcc_lo, 0x33333333
  s_mov_b32 vcc_hi, 0x33333333
  v_cndmask_b32_dpp v163, v100, v162, vcc row_shr:2 row_mask:0xf bank_mask:0xf bound_ctrl:0
  v_cndmask_b32_dpp v161, v102, v160, vcc row_shr:2 row_mask:0xf bank_mask:0xf bound_ctrl:0
  v_cndmask_b32_dpp v105, v108, v104, vcc row_shr:2 row_mask:0xf bank_mask:0xf bound_ctrl:0
  v_cndmask_b32_dpp v107, v110, v106, vcc row_shr:2 row_mask:0xf bank_mask:0xf bound_ctrl:0
  v_cndmask_b32_dpp v113, v116, v112, vcc row_shr:2 row_mask:0xf bank_mask:0xf bound_ctrl:0
  v_cndmask_b32_dpp v115, v118, v114, vcc row_shr:2 row_mask:0xf bank_mask:0xf bound_ctrl:0
  v_cndmask_b32_dpp v121, v124, v120, vcc row_shr:2 row_mask:0xf bank_mask:0xf bound_ctrl:0
  v_cndmask_b32_dpp v123, v126, v122, vcc row_shr:2 row_mask:0xf bank_mask:0xf bound_ctrl:0
  v_cndmask_b32_dpp v129, v132, v128, vcc row_shr:2 row_mask:0xf bank_mask:0xf bound_ctrl:0
  v_cndmask_b32_dpp v131, v134, v130, vcc row_shr:2 row_mask:0xf bank_mask:0xf bound_ctrl:0
  v_cndmask_b32_dpp v137, v140, v136, vcc row_shr:2 row_mask:0xf bank_mask:0xf bound_ctrl:0
  v_cndmask_b32_dpp v139, v142, v138, vcc row_shr:2 row_mask:0xf bank_mask:0xf bound_ctrl:0
  v_cndmask_b32_dpp v145, v148, v144, vcc row_shr:2 row_mask:0xf bank_mask:0xf bound_ctrl:0
  v_cndmask_b32_dpp v147, v150, v146, vcc row_shr:2 row_mask:0xf bank_mask:0xf bound_ctrl:0
  v_cndmask_b32_dpp v153, v156, v152, vcc row_shr:2 row_mask:0xf bank_mask:0xf bound_ctrl:0
  v_cndmask_b32_dpp v155, v158, v154, vcc row_shr:2 row_mask:0xf bank_mask:0xf bound_ctrl:0
  s_not_b64 vcc, vcc
  v_cndmask_b32_dpp v101, v162, v100, vcc row_shl:2 row_mask:0xf bank_mask:0xf bound_ctrl:0
  v_cndmask_b32_dpp v103, v160, v102, vcc row_shl:2 row_mask:0xf bank_mask:0xf bound_ctrl:0
  v_cndmask_b32_dpp v109, v104, v108, vcc row_shl:2 row_mask:0xf bank_mask:0xf bound_ctrl:0
  v_cndmask_b32_dpp v111, v106, v110, vcc row_shl:2 row_mask:0xf bank_mask:0xf bound_ctrl:0
  v_cndmask_b32_dpp v117, v112, v116, vcc row_shl:2 row_mask:0xf bank_mask:0xf bound_ctrl:0
  v_cndmask_b32_dpp v119, v114, v118, vcc row_shl:2 row_mask:0xf bank_mask:0xf bound_ctrl:0
  v_cndmask_b32_dpp v125, v120, v124, vcc row_shl:2 row_mask:0xf bank_mask:0xf bound_ctrl:0
  v_cndmask_b32_dpp v127, v122, v126, vcc row_shl:2 row_mask:0xf bank_mask:0xf bound_ctrl:0
  v_cndmask_b32_dpp v133, v128, v132, vcc row_shl:2 row_mask:0xf bank_mask:0xf bound_ctrl:0
  v_cndmask_b32_dpp v135, v130, v134, vcc row_shl:2 row_mask:0xf bank_mask:0xf bound_ctrl:0
  v_cndmask_b32_dpp v141, v136, v140, vcc row_shl:2 row_mask:0xf bank_mask:0xf bound_ctrl:0
  v_cndmask_b32_dpp v143, v138, v142, vcc row_shl:2 row_mask:0xf bank_mask:0xf bound_ctrl:0
  v_cndmask_b32_dpp v149, v144, v148, vcc row_shl:2 row_mask:0xf bank_mask:0xf bound_ctrl:0
  v_cndmask_b32_dpp v151, v146, v150, vcc row_shl:2 row_mask:0xf bank_mask:0xf bound_ctrl:0
  v_cndmask_b32_dpp v157, v152, v156, vcc row_shl:2 row_mask:0xf bank_mask:0xf bound_ctrl:0
  v_cndmask_b32_dpp v159, v154, v158, vcc row_shl:2 row_mask:0xf bank_mask:0xf bound_ctrl:0
  s_mov_b32 vcc_lo, 0x55555555
  s_mov_b32 vcc_hi, 0x55555555
  v_cndmask_b32_dpp v164, v161, v163, vcc row_shr:1 row_mask:0xf bank_mask:0xf bound_ctrl:0
  v_cndmask_b32_dpp v166, v103, v101, vcc row_shr:1 row_mask:0xf bank_mask:0xf bound_ctrl:0
  v_cndmask_b32_dpp v168, v107, v105, vcc row_shr:1 row_mask:0xf bank_mask:0xf bound_ctrl:0
  v_cndmask_b32_dpp v170, v111, v109, vcc row_shr:1 row_mask:0xf bank_mask:0xf bound_ctrl:0
  v_cndmask_b32_dpp v172, v115, v113, vcc row_shr:1 row_mask:0xf bank_mask:0xf bound_ctrl:0
  v_cndmask_b32_dpp v174, v119, v117, vcc row_shr:1 row_mask:0xf bank_mask:0xf bound_ctrl:0
  v_cndmask_b32_dpp v176, v123, v121, vcc row_shr:1 row_mask:0xf bank_mask:0xf bound_ctrl:0
  v_cndmask_b32_dpp v178, v127, v125, vcc row_shr:1 row_mask:0xf bank_mask:0xf bound_ctrl:0
  v_cndmask_b32_dpp v180, v131, v129, vcc row_shr:1 row_mask:0xf bank_mask:0xf bound_ctrl:0
  v_cndmask_b32_dpp v182, v135, v133, vcc row_shr:1 row_mask:0xf bank_mask:0xf bound_ctrl:0
  v_cndmask_b32_dpp v188, v139, v137, vcc row_shr:1 row_mask:0xf bank_mask:0xf bound_ctrl:0
  v_cndmask_b32_dpp v190, v143, v141, vcc row_shr:1 row_mask:0xf bank_mask:0xf bound_ctrl:0
  v_cndmask_b32_dpp v192, v147, v145, vcc row_shr:1 row_mask:0xf bank_mask:0xf bound_ctrl:0
  v_cndmask_b32_dpp v194, v151, v149, vcc row_shr:1 row_mask:0xf bank_mask:0xf bound_ctrl:0
  v_cndmask_b32_dpp v196, v155, v153, vcc row_shr:1 row_mask:0xf bank_mask:0xf bound_ctrl:0
  v_cndmask_b32_dpp v198, v159, v157, vcc row_shr:1 row_mask:0xf bank_mask:0xf bound_ctrl:0
  s_not_b64 vcc, vcc
  v_cndmask_b32_dpp v165, v163, v161, vcc row_shl:1 row_mask:0xf bank_mask:0xf bound_ctrl:0
  v_cndmask_b32_dpp v167, v101, v103, vcc row_shl:1 row_mask:0xf bank_mask:0xf bound_ctrl:0
  v_cndmask_b32_dpp v169, v105, v107, vcc row_shl:1 row_mask:0xf bank_mask:0xf bound_ctrl:0
  v_cndmask_b32_dpp v171, v109, v111, vcc row_shl:1 row_mask:0xf bank_mask:0xf bound_ctrl:0
  v_cndmask_b32_dpp v173, v113, v115, vcc row_shl:1 row_mask:0xf bank_mask:0xf bound_ctrl:0
  v_cndmask_b32_dpp v175, v117, v119, vcc row_shl:1 row_mask:0xf bank_mask:0xf bound_ctrl:0
  v_cndmask_b32_dpp v177, v121, v123, vcc row_shl:1 row_mask:0xf bank_mask:0xf bound_ctrl:0
  v_cndmask_b32_dpp v179, v125, v127, vcc row_shl:1 row_mask:0xf bank_mask:0xf bound_ctrl:0
  v_cndmask_b32_dpp v181, v129, v131, vcc row_shl:1 row_mask:0xf bank_mask:0xf bound_ctrl:0
  v_cndmask_b32_dpp v183, v133, v135, vcc row_shl:1 row_mask:0xf bank_mask:0xf bound_ctrl:0
  v_cndmask_b32_dpp v189, v137, v139, vcc row_shl:1 row_mask:0xf bank_mask:0xf bound_ctrl:0
  v_cndmask_b32_dpp v191, v141, v143, vcc row_shl:1 row_mask:0xf bank_mask:0xf bound_ctrl:0
  v_cndmask_b32_dpp v193, v145, v147, vcc row_shl:1 row_mask:0xf bank_mask:0xf bound_ctrl:0
  v_cndmask_b32_dpp v195, v149, v151, vcc row_shl:1 row_mask:0xf bank_mask:0xf bound_ctrl:0
  v_cndmask_b32_dpp v197, v153, v155, vcc row_shl:1 row_mask:0xf bank_mask:0xf bound_ctrl:0
  v_cndmask_b32_dpp v199, v157, v159, vcc row_shl:1 row_mask:0xf bank_mask:0xf bound_ctrl:0
  s_nop 1
  v_permlane16_swap_b32 v164, v180
  v_permlane16_swap_b32 v165, v181
  v_permlane16_swap_b32 v166, v182
  v_permlane16_swap_b32 v167, v183
  v_permlane16_swap_b32 v168, v188
  v_permlane16_swap_b32 v169, v189
  v_permlane16_swap_b32 v170, v190
  v_permlane16_swap_b32 v171, v191
  v_permlane16_swap_b32 v172, v192
  v_permlane16_swap_b32 v173, v193
  v_permlane16_swap_b32 v174, v194
  v_permlane16_swap_b32 v175, v195
  v_permlane16_swap_b32 v176, v196
  v_permlane16_swap_b32 v177, v197
  v_permlane16_swap_b32 v178, v198
  v_permlane16_swap_b32 v179, v199
  s_nop 1
  v_cvt_pk_bf16_f32 v12, v12, -v13
  v_cvt_pk_bf16_f32 v44, v44, -v45
  v_cvt_pk_bf16_f32 v48, v48, -v49
  v_cvt_pk_bf16_f32 v52, v52, -v53
  v_cvt_pk_bf16_f32 v58, v58, -v59
  v_cvt_pk_bf16_f32 v82, v82, -v83
  v_cvt_pk_bf16_f32 v84, v84, -v85
  v_cvt_pk_bf16_f32 v66, v66, -v67
  v_cvt_pk_bf16_f32 v56, v56, -v57
  v_cvt_pk_bf16_f32 v60, v60, -v61
  v_cvt_pk_bf16_f32 v64, v64, -v65
  v_cvt_pk_bf16_f32 v68, v68, -v69
  v_cvt_pk_bf16_f32 v88, v88, -v89
  v_cvt_pk_bf16_f32 v74, v74, -v75
  v_cvt_pk_bf16_f32 v90, v90, -v91
  v_cvt_pk_bf16_f32 v80, v80, -v81
  v_cvt_pk_bf16_f32 v46, v46, -v47
  v_cvt_pk_bf16_f32 v54, v54, -v55
  v_cvt_pk_bf16_f32 v62, v62, -v63
  v_cvt_pk_bf16_f32 v70, v70, -v71
  v_cvt_pk_bf16_f32 v92, v92, -v93
  v_cvt_pk_bf16_f32 v86, v86, -v87
  v_cvt_pk_bf16_f32 v94, v94, -v95
  v_cvt_pk_bf16_f32 v72, v72, -v73
  v_cvt_pk_bf16_f32 v50, v50, -v51
  v_cvt_pk_bf16_f32 v76, v76, -v77
  v_cvt_pk_bf16_f32 v78, v78, -v79
  s_nop 1
  s_mov_b32 vcc_lo, 0xff00ff
  s_mov_b32 vcc_hi, 0xff00ff
  v_cndmask_b32_dpp v13, v56, v12, vcc row_shr:8 row_mask:0xf bank_mask:0xf bound_ctrl:0
  v_cndmask_b32_dpp v45, v60, v44, vcc row_shr:8 row_mask:0xf bank_mask:0xf bound_ctrl:0
  v_cndmask_b32_dpp v49, v64, v48, vcc row_shr:8 row_mask:0xf bank_mask:0xf bound_ctrl:0
  v_cndmask_b32_dpp v53, v68, v52, vcc row_shr:8 row_mask:0xf bank_mask:0xf bound_ctrl:0
  v_cndmask_b32_dpp v59, v88, v58, vcc row_shr:8 row_mask:0xf bank_mask:0xf bound_ctrl:0
  v_cndmask_b32_dpp v83, v74, v82, vcc row_shr:8 row_mask:0xf bank_mask:0xf bound_ctrl:0
  v_cndmask_b32_dpp v85, v90, v84, vcc row_shr:8 row_mask:0xf bank_mask:0xf bound_ctrl:0
  v_cndmask_b32_dpp v67, v80, v66, vcc row_shr:8 row_mask:0xf bank_mask:0xf bound_ctrl:0
  v_cndmask_b32_dpp v47, v72, v46, vcc row_shr:8 row_mask:0xf bank_mask:0xf bound_ctrl:0
  v_cndmask_b32_dpp v55, v50, v54, vcc row_shr:8 row_mask:0xf bank_mask:0xf bound_ctrl:0
  v_cndmask_b32_dpp v63, v76, v62, vcc row_shr:8 row_mask:0xf bank_mask:0xf bound_ctrl:0
  v_cndmask_b32_dpp v71, v78, v70, vcc row_shr:8 row_mask:0xf bank_mask:0xf bound_ctrl:0
  v_cndmask_b32_dpp v93, v98, v92, vcc row_shr:8 row_mask:0xf bank_mask:0xf bound_ctrl:0
  v_cndmask_b32_dpp v87, v28, v86, vcc row_shr:8 row_mask:0xf bank_mask:0xf bound_ctrl:0
  v_cndmask_b32_dpp v95, v30, v94, vcc row_shr:8 row_mask:0xf bank_mask:0xf bound_ctrl:0
  v_cndmask_b32_dpp v97, v40, v96, vcc row_shr:8 row_mask:0xf bank_mask:0xf bound_ctrl:0
  s_not_b64 vcc, vcc
  v_cndmask_b32_dpp v57, v12, v56, vcc row_shl:8 row_mask:0xf bank_mask:0xf bound_ctrl:0
  v_cndmask_b32_dpp v61, v44, v60, vcc row_shl:8 row_mask:0xf bank_mask:0xf bound_ctrl:0
  v_cndmask_b32_dpp v65, v48, v64, vcc row_shl:8 row_mask:0xf bank_mask:0xf bound_ctrl:0
  v_cndmask_b32_dpp v69, v52, v68, vcc row_shl:8 row_mask:0xf bank_mask:0xf bound_ctrl:0
  v_cndmask_b32_dpp v89, v58, v88, vcc row_shl:8 row_mask:0xf bank_mask:0xf bound_ctrl:0
  v_cndmask_b32_dpp v75, v82, v74, vcc row_shl:8 row_mask:0xf bank_mask:0xf bound_ctrl:0
  v_cndmask_b32_dpp v91, v84, v90, vcc row_shl:8 row_mask:0xf bank_mask:0xf bound_ctrl:0
  v_cndmask_b32_dpp v81, v66, v80, vcc row_shl:8 row_mask:0xf bank_mask:0xf bound_ctrl:0
  v_cndmask_b32_dpp v73, v46, v72, vcc row_shl:8 row_mask:0xf bank_mask:0xf bound_ctrl:0
  v_cndmask_b32_dpp v51, v54, v50, vcc row_shl:8 row_mask:0xf bank_mask:0xf bound_ctrl:0
  v_cndmask_b32_dpp v77, v62, v76, vcc row_shl:8 row_mask:0xf bank_mask:0xf bound_ctrl:0
  v_cndmask_b32_dpp v79, v70, v78, vcc row_shl:8 row_mask:0xf bank_mask:0xf bound_ctrl:0
  v_cndmask_b32_dpp v99, v92, v98, vcc row_shl:8 row_mask:0xf bank_mask:0xf bound_ctrl:0
  v_cndmask_b32_dpp v29, v86, v28, vcc row_shl:8 row_mask:0xf bank_mask:0xf bound_ctrl:0
  v_cndmask_b32_dpp v31, v94, v30, vcc row_shl:8 row_mask:0xf bank_mask:0xf bound_ctrl:0
  v_cndmask_b32_dpp v41, v96, v40, vcc row_shl:8 row_mask:0xf bank_mask:0xf bound_ctrl:0
  s_mov_b32 vcc_lo, 0xf0f0f0f
  s_mov_b32 vcc_hi, 0xf0f0f0f
  v_cndmask_b32_dpp v12, v59, v13, vcc row_shr:4 row_mask:0xf bank_mask:0xf bound_ctrl:0
  v_cndmask_b32_dpp v44, v83, v45, vcc row_shr:4 row_mask:0xf bank_mask:0xf bound_ctrl:0
  v_cndmask_b32_dpp v48, v85, v49, vcc row_shr:4 row_mask:0xf bank_mask:0xf bound_ctrl:0
  v_cndmask_b32_dpp v52, v67, v53, vcc row_shr:4 row_mask:0xf bank_mask:0xf bound_ctrl:0
  v_cndmask_b32_dpp v56, v89, v57, vcc row_shr:4 row_mask:0xf bank_mask:0xf bound_ctrl:0
  v_cndmask_b32_dpp v60, v75, v61, vcc row_shr:4 row_mask:0xf bank_mask:0xf bound_ctrl:0
  v_cndmask_b32_dpp v64, v91, v65, vcc row_shr:4 row_mask:0xf bank_mask:0xf bound_ctrl:0
  v_cndmask_b32_dpp v68, v81, v69, vcc row_shr:4 row_mask:0xf bank_mask:0xf bound_ctrl:0
  v_cndmask_b32_dpp v46, v93, v47, vcc row_shr:4 row_mask:0xf bank_mask:0xf bound_ctrl:0
  v_cndmask_b32_dpp v54, v87, v55, vcc row_shr:4 row_mask:0xf bank_mask:0xf bound_ctrl:0
  v_cndmask_b32_dpp v62, v95, v63, vcc row_shr:4 row_mask:0xf bank_mask:0xf bound_ctrl:0
  v_cndmask_b32_dpp v70, v97, v71, vcc row_shr:4 row_mask:0xf bank_mask:0xf bound_ctrl:0
  v_cndmask_b32_dpp v72, v99, v73, vcc row_shr:4 row_mask:0xf bank_mask:0xf bound_ctrl:0
  v_cndmask_b32_dpp v50, v29, v51, vcc row_shr:4 row_mask:0xf bank_mask:0xf bound_ctrl:0
  v_cndmask_b32_dpp v76, v31, v77, vcc row_shr:4 row_mask:0xf bank_mask:0xf bound_ctrl:0
  v_cndmask_b32_dpp v78, v41, v79, vcc row_shr:4 row_mask:0xf bank_mask:0xf bound_ctrl:0
  s_not_b64 vcc, vcc
  v_cndmask_b32_dpp v58, v13, v59, vcc row_shl:4 row_mask:0xf bank_mask:0xf bound_ctrl:0
  v_cndmask_b32_dpp v82, v45, v83, vcc row_shl:4 row_mask:0xf bank_mask:0xf bound_ctrl:0
  v_cndmask_b32_dpp v84, v49, v85, vcc row_shl:4 row_mask:0xf bank_mask:0xf bound_ctrl:0
  v_cndmask_b32_dpp v66, v53, v67, vcc row_shl:4 row_mask:0xf bank_mask:0xf bound_ctrl:0
  v_cndmask_b32_dpp v88, v57, v89, vcc row_shl:4 row_mask:0xf bank_mask:0xf bound_ctrl:0
  v_cndmask_b32_dpp v74, v61, v75, vcc row_shl:4 row_mask:0xf bank_mask:0xf bound_ctrl:0
  v_cndmask_b32_dpp v90, v65, v91, vcc row_shl:4 row_mask:0xf bank_mask:0xf bound_ctrl:0
  v_cndmask_b32_dpp v80, v69, v81, vcc row_shl:4 row_mask:0xf bank_mask:0xf bound_ctrl:0
  v_cndmask_b32_dpp v92, v47, v93, vcc row_shl:4 row_mask:0xf bank_mask:0xf bound_ctrl:0
  v_cndmask_b32_dpp v86, v55, v87, vcc row_shl:4 row_mask:0xf bank_mask:0xf bound_ctrl:0
  v_cndmask_b32_dpp v94, v63, v95, vcc row_shl:4 row_mask:0xf bank_mask:0xf bound_ctrl:0
  v_cndmask_b32_dpp v96, v71, v97, vcc row_shl:4 row_mask:0xf bank_mask:0xf bound_ctrl:0
  v_cndmask_b32_dpp v98, v73, v99, vcc row_shl:4 row_mask:0xf bank_mask:0xf bound_ctrl:0
  v_cndmask_b32_dpp v28, v51, v29, vcc row_shl:4 row_mask:0xf bank_mask:0xf bound_ctrl:0
  v_cndmask_b32_dpp v30, v77, v31, vcc row_shl:4 row_mask:0xf bank_mask:0xf bound_ctrl:0
  v_cndmask_b32_dpp v40, v79, v41, vcc row_shl:4 row_mask:0xf bank_mask:0xf bound_ctrl:0
  s_mov_b32 vcc_lo, 0x33333333
  s_mov_b32 vcc_hi, 0x33333333
  v_cndmask_b32_dpp v13, v48, v12, vcc row_shr:2 row_mask:0xf bank_mask:0xf bound_ctrl:0
  v_cndmask_b32_dpp v45, v52, v44, vcc row_shr:2 row_mask:0xf bank_mask:0xf bound_ctrl:0
  v_cndmask_b32_dpp v59, v84, v58, vcc row_shr:2 row_mask:0xf bank_mask:0xf bound_ctrl:0
  v_cndmask_b32_dpp v83, v66, v82, vcc row_shr:2 row_mask:0xf bank_mask:0xf bound_ctrl:0
  v_cndmask_b32_dpp v57, v64, v56, vcc row_shr:2 row_mask:0xf bank_mask:0xf bound_ctrl:0
  v_cndmask_b32_dpp v61, v68, v60, vcc row_shr:2 row_mask:0xf bank_mask:0xf bound_ctrl:0
  v_cndmask_b32_dpp v89, v90, v88, vcc row_shr:2 row_mask:0xf bank_mask:0xf bound_ctrl:0
  v_cndmask_b32_dpp v75, v80, v74, vcc row_shr:2 row_mask:0xf bank_mask:0xf bound_ctrl:0
  v_cndmask_b32_dpp v47, v62, v46, vcc row_shr:2 row_mask:0xf bank_mask:0xf bound_ctrl:0
  v_cndmask_b32_dpp v55, v70, v54, vcc row_shr:2 row_mask:0xf bank_mask:0xf bound_ctrl:0
  v_cndmask_b32_dpp v93, v94, v92, vcc row_shr:2 row_mask:0xf bank_mask:0xf bound_ctrl:0
  v_cndmask_b32_dpp v87, v96, v86, vcc row_shr:2 row_mask:0xf bank_mask:0xf bound_ctrl:0
  v_cndmask_b32_dpp v73, v76, v72, vcc row_shr:2 row_mask:0xf bank_mask:0xf bound_ctrl:0
  v_cndmask_b32_dpp v51, v78, v50, vcc row_shr:2 row_mask:0xf bank_mask:0xf bound_ctrl:0
  v_cndmask_b32_dpp v99, v30, v98, vcc row_shr:2 row_mask:0xf bank_mask:0xf bound_ctrl:0
  v_cndmask_b32_dpp v29, v40, v28, vcc row_shr:2 row_mask:0xf bank_mask:0xf bound_ctrl:0
  s_not_b64 vcc, vcc
  v_cndmask_b32_dpp v49, v12, v48, vcc row_shl:2 row_mask:0xf bank_mask:0xf bound_ctrl:0
  v_cndmask_b32_dpp v53, v44, v52, vcc row_shl:2 row_mask:0xf bank_mask:0xf bound_ctrl:0
  v_cndmask_b32_dpp v85, v58, v84, vcc row_shl:2 row_mask:0xf bank_mask:0xf bound_ctrl:0
  v_cndmask_b32_dpp v67, v82, v66, vcc row_shl:2 row_mask:0xf bank_mask:0xf bound_ctrl:0
  v_cndmask_b32_dpp v65, v56, v64, vcc row_shl:2 row_mask:0xf bank_mask:0xf bound_ctrl:0
  v_cndmask_b32_dpp v69, v60, v68, vcc row_shl:2 row_mask:0xf bank_mask:0xf bound_ctrl:0
  v_cndmask_b32_dpp v91, v88, v90, vcc row_shl:2 row_mask:0xf bank_mask:0xf bound_ctrl:0
  v_cndmask_b32_dpp v81, v74, v80, vcc row_shl:2 row_mask:0xf bank_mask:0xf bound_ctrl:0
  v_cndmask_b32_dpp v63, v46, v62, vcc row_shl:2 row_mask:0xf bank_mask:0xf bound_ctrl:0
  v_cndmask_b32_dpp v71, v54, v70, vcc row_shl:2 row_mask:0xf bank_mask:0xf bound_ctrl:0
  v_cndmask_b32_dpp v95, v92, v94, vcc row_shl:2 row_mask:0xf bank_mask:0xf bound_ctrl:0
  v_cndmask_b32_dpp v97, v86, v96, vcc row_shl:2 row_mask:0xf bank_mask:0xf bound_ctrl:0
  v_cndmask_b32_dpp v77, v72, v76, vcc row_shl:2 row_mask:0xf bank_mask:0xf bound_ctrl:0
  v_cndmask_b32_dpp v79, v50, v78, vcc row_shl:2 row_mask:0xf bank_mask:0xf bound_ctrl:0
  v_cndmask_b32_dpp v31, v98, v30, vcc row_shl:2 row_mask:0xf bank_mask:0xf bound_ctrl:0
  v_cndmask_b32_dpp v41, v28, v40, vcc row_shl:2 row_mask:0xf bank_mask:0xf bound_ctrl:0
  s_mov_b32 vcc_lo, 0x55555555
  s_mov_b32 vcc_hi, 0x55555555
  v_cndmask_b32_dpp v100, v45, v13, vcc row_shr:1 row_mask:0xf bank_mask:0xf bound_ctrl:0
  v_cndmask_b32_dpp v102, v53, v49, vcc row_shr:1 row_mask:0xf bank_mask:0xf bound_ctrl:0
  v_cndmask_b32_dpp v104, v83, v59, vcc row_shr:1 row_mask:0xf bank_mask:0xf bound_ctrl:0
  v_cndmask_b32_dpp v106, v67, v85, vcc row_shr:1 row_mask:0xf bank_mask:0xf bound_ctrl:0
  v_cndmask_b32_dpp v108, v61, v57, vcc row_shr:1 row_mask:0xf bank_mask:0xf bound_ctrl:0
  v_cndmask_b32_dpp v110, v69, v65, vcc row_shr:1 row_mask:0xf bank_mask:0xf bound_ctrl:0
  v_cndmask_b32_dpp v112, v75, v89, vcc row_shr:1 row_mask:0xf bank_mask:0xf bound_ctrl:0
  v_cndmask_b32_dpp v114, v81, v91, vcc row_shr:1 row_mask:0xf bank_mask:0xf bound_ctrl:0
  v_cndmask_b32_dpp v116, v55, v47, vcc row_shr:1 row_mask:0xf bank_mask:0xf bound_ctrl:0
  v_cndmask_b32_dpp v118, v71, v63, vcc row_shr:1 row_mask:0xf bank_mask:0xf bound_ctrl:0
  v_cndmask_b32_dpp v120, v87, v93, vcc row_shr:1 row_mask:0xf bank_mask:0xf bound_ctrl:0
  v_cndmask_b32_dpp v122, v97, v95, vcc row_shr:1 row_mask:0xf bank_mask:0xf bound_ctrl:0
  v_cndmask_b32_dpp v124, v51, v73, vcc row_shr:1 row_mask:0xf bank_mask:0xf bound_ctrl:0
  v_cndmask_b32_dpp v126, v79, v77, vcc row_shr:1 row_mask:0xf bank_mask:0xf bound_ctrl:0
  v_cndmask_b32_dpp v128, v29, v99, vcc row_shr:1 row_mask:0xf bank_mask:0xf bound_ctrl:0
  v_cndmask_b32_dpp v130, v41, v31, vcc row_shr:1 row_mask:0xf bank_mask:0xf bound_ctrl:0
  s_not_b64 vcc, vcc
  v_cndmask_b32_dpp v101, v13, v45, vcc row_shl:1 row_mask:0xf bank_mask:0xf bound_ctrl:0
  v_cndmask_b32_dpp v103, v49, v53, vcc row_shl:1 row_mask:0xf bank_mask:0xf bound_ctrl:0
  v_cndmask_b32_dpp v105, v59, v83, vcc row_shl:1 row_mask:0xf bank_mask:0xf bound_ctrl:0
  v_cndmask_b32_dpp v107, v85, v67, vcc row_shl:1 row_mask:0xf bank_mask:0xf bound_ctrl:0
  v_cndmask_b32_dpp v109, v57, v61, vcc row_shl:1 row_mask:0xf bank_mask:0xf bound_ctrl:0
  v_cndmask_b32_dpp v111, v65, v69, vcc row_shl:1 row_mask:0xf bank_mask:0xf bound_ctrl:0
  v_cndmask_b32_dpp v113, v89, v75, vcc row_shl:1 row_mask:0xf bank_mask:0xf bound_ctrl:0
  v_cndmask_b32_dpp v115, v91, v81, vcc row_shl:1 row_mask:0xf bank_mask:0xf bound_ctrl:0
  v_cndmask_b32_dpp v117, v47, v55, vcc row_shl:1 row_mask:0xf bank_mask:0xf bound_ctrl:0
  v_cndmask_b32_dpp v119, v63, v71, vcc row_shl:1 row_mask:0xf bank_mask:0xf bound_ctrl:0
  v_cndmask_b32_dpp v121, v93, v87, vcc row_shl:1 row_mask:0xf bank_mask:0xf bound_ctrl:0
  v_cndmask_b32_dpp v123, v95, v97, vcc row_shl:1 row_mask:0xf bank_mask:0xf bound_ctrl:0
  v_cndmask_b32_dpp v125, v73, v51, vcc row_shl:1 row_mask:0xf bank_mask:0xf bound_ctrl:0
  v_cndmask_b32_dpp v127, v77, v79, vcc row_shl:1 row_mask:0xf bank_mask:0xf bound_ctrl:0
  v_cndmask_b32_dpp v129, v99, v29, vcc row_shl:1 row_mask:0xf bank_mask:0xf bound_ctrl:0
  v_cndmask_b32_dpp v131, v31, v41, vcc row_shl:1 row_mask:0xf bank_mask:0xf bound_ctrl:0
  s_nop 1
  v_permlane16_swap_b32 v100, v116
  v_permlane16_swap_b32 v101, v117
  v_permlane16_swap_b32 v102, v118
  v_permlane16_swap_b32 v103, v119
  v_permlane16_swap_b32 v104, v120
  v_permlane16_swap_b32 v105, v121
  v_permlane16_swap_b32 v106, v122
  v_permlane16_swap_b32 v107, v123
  v_permlane16_swap_b32 v108, v124
  v_permlane16_swap_b32 v109, v125
  v_permlane16_swap_b32 v110, v126
  v_permlane16_swap_b32 v111, v127
  v_permlane16_swap_b32 v112, v128
  v_permlane16_swap_b32 v113, v129
  v_permlane16_swap_b32 v114, v130
  v_permlane16_swap_b32 v115, v131
  s_nop 1
  v_mfma_f32_32x32x16_bf16 v[32:47], v[100:103], v[164:167], 0
  v_mfma_f32_32x32x16_bf16 v[32:47], v[104:107], v[168:171], v[32:47]
  v_mfma_f32_32x32x16_bf16 v[32:47], v[108:111], v[172:175], v[32:47]
  v_mfma_f32_32x32x16_bf16 v[32:47], v[112:115], v[176:179], v[32:47]
  v_mfma_f32_32x32x16_bf16 v[32:47], v[116:119], v[180:183], v[32:47]
  v_mfma_f32_32x32x16_bf16 v[32:47], v[120:123], v[188:191], v[32:47]
  v_mfma_f32_32x32x16_bf16 v[32:47], v[124:127], v[192:195], v[32:47]
  v_mfma_f32_32x32x16_bf16 v[32:47], v[128:131], v[196:199], v[32:47]
  s_lshl_b32 s4, s60, 12
  s_add_u32 s4, s4, 67584
  v_lshlrev_b32 v3, 4, v1
  v_add_u32 v3, s4, v3
  s_cmp_eq_u32 s61, 0
  s_cbranch_scc1 L_kg_a
  s_nop 5
  ds_write_b128 v3, v[32:35] offset:0
  ds_write_b128 v3, v[36:39] offset:1024
  ds_write_b128 v3, v[40:43] offset:2048
  ds_write_b128 v3, v[44:47] offset:3072
L_kg_a:
  s_waitcnt lgkmcnt(0)
  s_barrier
  s_cmp_eq_u32 s61, 0
  s_cbranch_scc1 L_kg_m0
  s_mov_b32 s64, 0
  s_branch L_kg_b
L_kg_u1:
  s_mov_b32 s64, 1
  global_load_dwordx4 v[192:195], v184, s[42:43] sc1
  global_load_dwordx4 v[196:199], v185, s[42:43] sc1
  global_load_dwordx4 v[200:203], v186, s[42:43] sc1
  global_load_dwordx4 v[204:207], v187, s[42:43] sc1
  s_branch L_kg_b
L_kg_m0:
  ds_read_b128 v[64:67], v3 offset:0
  ds_read_b128 v[68:71], v3 offset:1024
  ds_read_b128 v[72:75], v3 offset:2048
  ds_read_b128 v[76:79], v3 offset:3072
  s_mul_i32 s4, s60, 17664
  s_add_u32 s4, s4, 784
  v_and_b32 v4, 31, v1
  v_lshlrev_b32 v4, 4, v4
  v_sub_u32 v4, s4, v4
  v_and_b32 v5, 1, v1
  v_cmp_eq_u32 vcc, 1, v5
  s_waitcnt lgkmcnt(0)
  v_add_f32 v32, v32, v64
  v_add_f32 v33, v33, v65
  v_add_f32 v34, v34, v66
  v_add_f32 v35, v35, v67
  v_add_f32 v36, v36, v68
  v_add_f32 v37, v37, v69
  v_add_f32 v38, v38, v70
  v_add_f32 v39, v39, v71
  v_add_f32 v40, v40, v72
  v_add_f32 v41, v41, v73
  v_add_f32 v42, v42, v74
  v_add_f32 v43, v43, v75
  v_add_f32 v44, v44, v76
  v_add_f32 v45, v45, v77
  v_add_f32 v46, v46, v78
  v_add_f32 v47, v47, v79
  v_cndmask_b32 v80, v35, v36, vcc
  v_cndmask_b32 v81, v37, v38, vcc
  v_cndmask_b32 v82, v39, v40, vcc
  v_cndmask_b32 v83, v41, v42, vcc
  s_mov_b32 exec_lo, -1
  s_mov_b32 exec_hi, 0
  v_cvt_pk_bf16_f32 v64, v39, v38
  v_cvt_pk_bf16_f32 v65, v37, v36
  v_cvt_pk_bf16_f32 v66, v35, v34
  v_cvt_pk_bf16_f32 v67, v33, v32
  ds_write_b128 v4, v[64:67] offset:3584
  v_cvt_pk_bf16_f32 v68, v44, v43
  v_cvt_pk_bf16_f32 v69, v42, v42
  v_cvt_pk_bf16_f32 v70, v42, v41
  v_cvt_pk_bf16_f32 v71, v40, v40
  ds_write_b128 v4, v[68:71] offset:3072
  v_cvt_pk_bf16_f32 v72, v47, v47
  v_cvt_pk_bf16_f32 v73, v46, v46
  v_cvt_pk_bf16_f32 v74, v46, v45
  v_cvt_pk_bf16_f32 v75, v45, v45
  ds_write_b128 v4, v[72:75] offset:2560
  s_mov_b32 exec_lo, 0
  s_mov_b32 exec_hi, -1
  v_cvt_pk_bf16_f32 v84, v34, v34
  v_cvt_pk_bf16_f32 v85, v33, v33
  v_cvt_pk_bf16_f32 v86, v33, v32
  v_cvt_pk_bf16_f32 v87, v32, v32
  ds_write_b128 v4, v[84:87] offset:2048
  v_cvt_pk_bf16_f32 v88, v36, v36
  v_cvt_pk_bf16_f32 v89, v36, v80
  v_cvt_pk_bf16_f32 v90, v35, v35
  v_cvt_pk_bf16_f32 v91, v35, v35
  ds_write_b128 v4, v[88:91] offset:1536
  v_cvt_pk_bf16_f32 v92, v38, v38
  v_cvt_pk_bf16_f32 v93, v38, v81
  v_cvt_pk_bf16_f32 v94, v37, v37
  v_cvt_pk_bf16_f32 v95, v37, v37
  ds_write_b128 v4, v[92:95] offset:1024
  v_cvt_pk_bf16_f32 v96, v40, v40
  v_cvt_pk_bf16_f32 v97, v40, v82
  v_cvt_pk_bf16_f32 v98, v39, v39
  v_cvt_pk_bf16_f32 v99, v39, v39
  ds_write_b128 v4, v[96:99] offset:512
  v_cvt_pk_bf16_f32 v100, v42, v42
  v_cvt_pk_bf16_f32 v101, v42, v83
  v_cvt_pk_bf16_f32 v102, v41, v41
  v_cvt_pk_bf16_f32 v103, v41, v41
  ds_write_b128 v4, v[100:103] offset:0
  s_mov_b64 exec, -1
  v_mov_b32 v64, 0
  v_mov_b32 v65, 0
  v_mov_b32 v66, 0
  v_mov_b32 v67, 0
  s_mul_i32 s4, s60, 17664
  s_add_u32 s4, s4, 256
  v_lshlrev_b32 v4, 4, v1
  v_add_u32 v5, 4096, v4
  v_cmp_gt_u32 vcc, 2, v1
  s_nop 1
  v_cndmask_b32 v4, v5, v4, vcc
  v_add_u32 v4, s4, v4
  s_mov_b64 exec, 0xfffff
  ds_write_b128 v4, v[64:67]
  s_mov_b64 exec, -1
  v_mov_b32 v8, 0
  v_mov_b32 v9, 0
  v_mov_b32 v10, 0
  v_mov_b32 v11, 0
  s_mul_i32 s4, s60, 4608
  s_add_u32 s4, s4, 35584
  v_lshlrev_b32 v12, 4, v1
  v_add_u32 v13, 4096, v12
  v_cmp_gt_u32 vcc, 32, v1
  s_nop 1
  v_cndmask_b32 v12, v13, v12, vcc
  v_add_u32 v12, s4, v12
  s_mov_b32 exec_hi, 15
  ds_write_b128 v12, v[8:11]
  s_mov_b64 exec, -1
  s_waitcnt lgkmcnt(0)
L_kg_b:
  s_barrier
  s_mul_i32 s4, s60, 17664
  s_lshl_b32 s5, s61, 10
  s_add_u32 s4, s4, s5
  s_add_u32 s4, s4, 256
  v_lshlrev_b32 v4, 4, v1
  v_add_u32 v4, s4, v4
  ds_read_b128 v[64:67], v4 offset:0
  ds_read_b128 v[68:71], v4 offset:16
  ds_read_b128 v[88:91], v4 offset:2048
  ds_read_b128 v[92:95], v4 offset:2064
  ds_read_b128 v[112:115], v4 offset:4096
  ds_read_b128 v[116:119], v4 offset:4112
  s_waitcnt lgkmcnt(4)
  v_alignbit_b32 v72, v65, v64, 16
  v_mov_b32 v76, v65
  v_alignbit_b32 v80, v66, v65, 16
  v_alignbit_b32 v73, v66, v65, 16
  v_mov_b32 v77, v66
  v_alignbit_b32 v81, v67, v66, 16
  v_alignbit_b32 v74, v67, v66, 16
  v_mov_b32 v78, v67
  v_alignbit_b32 v82, v68, v67, 16
  v_alignbit_b32 v75, v68, v67, 16
  v_mov_b32 v79, v68
  v_alignbit_b32 v83, v69, v68, 16
  ds_write_b128 v4, v[72:75] offset:4416
  ds_write_b128 v4, v[76:79] offset:8832
  ds_write_b128 v4, v[80:83] offset:13248
  s_waitcnt lgkmcnt(5)
  v_alignbit_b32 v96, v89, v88, 16
  v_mov_b32 v100, v89
  v_alignbit_b32 v104, v90, v89, 16
  v_alignbit_b32 v97, v90, v89, 16
  v_mov_b32 v101, v90
  v_alignbit_b32 v105, v91, v90, 16
  v_alignbit_b32 v98, v91, v90, 16
  v_mov_b32 v102, v91
  v_alignbit_b32 v106, v92, v91, 16
  v_alignbit_b32 v99, v92, v91, 16
  v_mov_b32 v103, v92
  v_alignbit_b32 v107, v93, v92, 16
  ds_write_b128 v4, v[96:99] offset:6464
  ds_write_b128 v4, v[100:103] offset:10880
  ds_write_b128 v4, v[104:107] offset:15296
  s_cmp_eq_u32 s61, 0
  s_cbranch_scc0 L_kg_c
  s_mov_b64 exec, 0xfffff
  s_waitcnt lgkmcnt(6)
  v_alignbit_b32 v120, v113, v112, 16
  v_mov_b32 v124, v113
  v_alignbit_b32 v128, v114, v113, 16
  v_alignbit_b32 v121, v114, v113, 16
  v_mov_b32 v125, v114
  v_alignbit_b32 v129, v115, v114, 16
  v_alignbit_b32 v122, v115, v114, 16
  v_mov_b32 v126, v115
  v_alignbit_b32 v130, v116, v115, 16
  v_alignbit_b32 v123, v116, v115, 16
  v_mov_b32 v127, v116
  v_alignbit_b32 v131, v117, v116, 16
  ds_write_b128 v4, v[120:123] offset:8512
  ds_write_b128 v4, v[124:127] offset:12928
  ds_write_b128 v4, v[128:131] offset:17344
  s_mov_b64 exec, -1
  s_branch L_kg_e
L_kg_c:
  s_cmp_eq_u32 s64, 1
  s_cbranch_scc1 L_kg_d
  s_mov_b32 s6, 0
L_u_spin:
  global_load_dword v238, v239, s[42:43] sc1
  global_load_dword v240, v239, s[42:43] offset:2048 sc1
  s_add_u32 s6, s6, 1
  s_waitcnt vmcnt(0)
  v_cmp_ne_u32 vcc, s49, v238
  v_cmp_ne_u32 s[4:5], s49, v240
  s_nop 0
  s_or_b64 vcc, vcc, s[4:5]
  s_cmp_ge_u32 s6, 20000
  s_cbranch_scc1 L_u_go
  s_cbranch_vccz L_u_go
  s_sleep 2
  s_branch L_u_spin
L_u_go:
  global_load_dwordx4 v[192:195], v184, s[42:43] sc1
  global_load_dwordx4 v[196:199], v185, s[42:43] sc1
  global_load_dwordx4 v[200:203], v186, s[42:43] sc1
  global_load_dwordx4 v[204:207], v187, s[42:43] sc1
L_kg_d:
  s_waitcnt vmcnt(0)
  s_lshl_b32 s5, s60, 6
  v_add_u32 v9, s5, v1
  v_lshrrev_b32 v8, 1, v9
  v_lshlrev_b32 v8, 4, v8
  v_and_b32 v9, 1, v9
  v_mul_u32_u24 v9, 4608, v9
  v_add_u32 v8, v8, v9
  v_add_u32 v8, 36096, v8
  ds_write_b128 v8, v[192:195] offset:0
  ds_write_b128 v8, v[196:199] offset:1024
  ds_write_b128 v8, v[200:203] offset:2048
  ds_write_b128 v8, v[204:207] offset:3072
L_kg_e:
  s_waitcnt lgkmcnt(0)
  s_barrier
  s_setprio 1
  v_and_b32 v168, 15, v1
  v_lshrrev_b32 v169, 4, v1
  v_and_b32 v170, 3, v168
  v_sub_u32 v170, 3, v170
  v_mul_u32_u24 v170, 4416, v170
  v_lshrrev_b32 v171, 2, v168
  v_lshlrev_b32 v171, 3, v171
  v_sub_u32 v170, v170, v171
  v_lshl_add_u32 v170, v169, 4, v170
  s_mul_i32 s4, s60, 17664
  s_add_u32 s4, s4, 280
  v_add_u32 v6, s4, v170
  s_lshl_b32 s5, s61, 6
  v_subrev_u32 v4, s5, v6
  v_lshlrev_b32 v170, 5, v168
  v_lshl_add_u32 v170, v169, 4, v170
  s_mul_i32 s4, s60, 4608
  s_add_u32 s4, s4, 35584
  v_add_u32 v7, s4, v170
  v_subrev_u32 v5, s5, v7
  ds_read_b128 v[72:75], v5 offset:448
  ds_read_b64 v[40:41], v4 offset:4032
  ds_read_b64 v[42:43], v4 offset:4040
  ds_read_b128 v[76:79], v5 offset:960
  ds_read_b64 v[44:45], v4 offset:3520
  ds_read_b64 v[46:47], v4 offset:3528
  ds_read_b128 v[80:83], v5 offset:1472
  ds_read_b64 v[48:49], v4 offset:3008
  ds_read_b64 v[50:51], v4 offset:3016
  ds_read_b128 v[84:87], v5 offset:1984
  ds_read_b64 v[52:53], v4 offset:2496
  ds_read_b64 v[54:55], v4 offset:2504
  ds_read_b128 v[88:91], v5 offset:2496
  ds_read_b64 v[56:57], v4 offset:1984
  ds_read_b64 v[58:59], v4 offset:1992
  ds_read_b128 v[92:95], v5 offset:3008
  ds_read_b64 v[60:61], v4 offset:1472
  ds_read_b64 v[62:63], v4 offset:1480
  ds_read_b128 v[96:99], v5 offset:3520
  ds_read_b64 v[64:65], v4 offset:960
  ds_read_b64 v[66:67], v4 offset:968
  ds_read_b128 v[100:103], v5 offset:4032
  ds_read_b64 v[68:69], v4 offset:448
  ds_read_b64 v[70:71], v4 offset:456
  v_lshlrev_b32 v172, 5, v168
  v_lshl_add_u32 v172, v169, 3, v172
  s_mul_i32 s4, s60, 4608
  s_lshl_b32 s5, s61, 11
  s_add_u32 s4, s4, s5
  s_add_u32 s4, s4, 36096
  v_add_u32 v173, s4, v172
  ds_read_b64 v[176:177], v173 offset:0
  ds_read_b64 v[178:179], v173 offset:512
  ds_read_b64 v[180:181], v173 offset:1024
  ds_read_b64 v[182:183], v173 offset:1536
  s_lshl_b32 s4, s46, 1
  s_add_u32 s4, s4, s60
  s_lshl_b32 s4, s4, 13
  s_lshl_b32 s5, s61, 12
  s_add_u32 s4, s4, s5
  s_add_u32 s4, s4, 0xb00000
  v_lshlrev_b32 v184, 1, v172
  v_add_u32 v184, s4, v184
  s_lshl_b32 s4, s45, 12
  s_add_u32 s4, s4, 44864
  v_lshlrev_b32 v186, 4, v1
  v_add_u32 v185, s4, v186
  s_xor_b32 s4, s45, 1
  s_lshl_b32 s4, s4, 12
  s_add_u32 s4, s4, 44864
  v_add_u32 v186, s4, v186
  s_lshl_b32 s5, s61, 11
  s_waitcnt lgkmcnt(0)
  ds_read_b128 v[136:139], v5 offset:320
  ds_read_b64 v[104:105], v4 offset:3904
  ds_read_b64 v[106:107], v4 offset:3912
  ds_read_b128 v[140:143], v5 offset:832
  ds_read_b64 v[108:109], v4 offset:3392
  ds_read_b64 v[110:111], v4 offset:3400
  ds_read_b128 v[144:147], v5 offset:1344
  ds_read_b64 v[112:113], v4 offset:2880
  ds_read_b64 v[114:115], v4 offset:2888
  ds_read_b128 v[148:151], v5 offset:1856
  ds_read_b64 v[116:117], v4 offset:2368
  ds_read_b64 v[118:119], v4 offset:2376
  ds_read_b128 v[152:155], v5 offset:2368
  ds_read_b64 v[120:121], v4 offset:1856
  ds_read_b64 v[122:123], v4 offset:1864
  ds_read_b128 v[156:159], v5 offset:2880
  ds_read_b64 v[124:125], v4 offset:1344
  ds_read_b64 v[126:127], v4 offset:1352
  ds_read_b128 v[160:163], v5 offset:3392
  ds_read_b64 v[128:129], v4 offset:832
  ds_read_b64 v[130:131], v4 offset:840
  ds_read_b128 v[164:167], v5 offset:3904
  ds_read_b64 v[132:133], v4 offset:320
  ds_read_b64 v[134:135], v4 offset:328
  v_mfma_f32_16x16x32_bf16 v[8:11], v[40:43], v[72:75], 0
  v_lshlrev_b32 v192, 16, v176
  v_and_b32 v193, 0xffff0000, v176
  v_mfma_f32_16x16x32_bf16 v[12:15], v[40:43], v[76:79], 0
  v_lshlrev_b32 v194, 16, v177
  v_and_b32 v195, 0xffff0000, v177
  v_mfma_f32_16x16x32_bf16 v[16:19], v[40:43], v[80:83], 0
  v_mul_f32 v192, s63, v192
  v_mul_f32 v193, s63, v193
  v_mfma_f32_16x16x32_bf16 v[20:23], v[40:43], v[84:87], 0
  v_mul_f32 v194, s63, v194
  v_mul_f32 v195, s63, v195
  v_mfma_f32_16x16x32_bf16 v[24:27], v[40:43], v[88:91], 0
  v_cvt_pk_bf16_f32 v176, v192, v193
  v_cvt_pk_bf16_f32 v177, v194, v195
  v_mfma_f32_16x16x32_bf16 v[28:31], v[40:43], v[92:95], 0
  v_lshlrev_b32 v192, 16, v176
  v_and_b32 v193, 0xffff0000, v176
  v_mfma_f32_16x16x32_bf16 v[32:35], v[40:43], v[96:99], 0
  v_lshlrev_b32 v194, 16, v177
  v_and_b32 v195, 0xffff0000, v177
  v_mfma_f32_16x16x32_bf16 v[36:39], v[40:43], v[100:103], 0
  v_lshlrev_b32 v196, 16, v178
  v_and_b32 v197, 0xffff0000, v178
  v_mfma_f32_16x16x32_bf16 v[12:15], v[44:47], v[72:75], v[12:15]
  v_lshlrev_b32 v198, 16, v179
  v_and_b32 v199, 0xffff0000, v179
  v_mfma_f32_16x16x32_bf16 v[16:19], v[44:47], v[76:79], v[16:19]
  v_mul_f32 v196, s63, v196
  v_mul_f32 v197, s63, v197
  v_mfma_f32_16x16x32_bf16 v[20:23], v[44:47], v[80:83], v[20:23]
  v_mul_f32 v198, s63, v198
  v_mul_f32 v199, s63, v199
  v_mfma_f32_16x16x32_bf16 v[24:27], v[44:47], v[84:87], v[24:27]
  v_cvt_pk_bf16_f32 v178, v196, v197
  v_cvt_pk_bf16_f32 v179, v198, v199
  v_mfma_f32_16x16x32_bf16 v[28:31], v[44:47], v[88:91], v[28:31]
  v_lshlrev_b32 v196, 16, v178
  v_and_b32 v197, 0xffff0000, v178
  v_mfma_f32_16x16x32_bf16 v[32:35], v[44:47], v[92:95], v[32:35]
  v_lshlrev_b32 v198, 16, v179
  v_and_b32 v199, 0xffff0000, v179
  v_mfma_f32_16x16x32_bf16 v[36:39], v[44:47], v[96:99], v[36:39]
  v_lshlrev_b32 v200, 16, v180
  v_and_b32 v201, 0xffff0000, v180
  v_mfma_f32_16x16x32_bf16 v[16:19], v[48:51], v[72:75], v[16:19]
  v_lshlrev_b32 v202, 16, v181
  v_and_b32 v203, 0xffff0000, v181
  v_mfma_f32_16x16x32_bf16 v[20:23], v[48:51], v[76:79], v[20:23]
  v_mul_f32 v200, s63, v200
  v_mul_f32 v201, s63, v201
  v_mfma_f32_16x16x32_bf16 v[24:27], v[48:51], v[80:83], v[24:27]
  v_mul_f32 v202, s63, v202
  v_mul_f32 v203, s63, v203
  v_mfma_f32_16x16x32_bf16 v[28:31], v[48:51], v[84:87], v[28:31]
  v_cvt_pk_bf16_f32 v180, v200, v201
  v_cvt_pk_bf16_f32 v181, v202, v203
  v_mfma_f32_16x16x32_bf16 v[32:35], v[48:51], v[88:91], v[32:35]
  v_lshlrev_b32 v200, 16, v180
  v_and_b32 v201, 0xffff0000, v180
  v_mfma_f32_16x16x32_bf16 v[36:39], v[48:51], v[92:95], v[36:39]
  v_lshlrev_b32 v202, 16, v181
  v_and_b32 v203, 0xffff0000, v181
  v_mfma_f32_16x16x32_bf16 v[20:23], v[52:55], v[72:75], v[20:23]
  v_lshlrev_b32 v204, 16, v182
  v_and_b32 v205, 0xffff0000, v182
  v_mfma_f32_16x16x32_bf16 v[24:27], v[52:55], v[76:79], v[24:27]
  v_lshlrev_b32 v206, 16, v183
  v_and_b32 v207, 0xffff0000, v183
  v_mfma_f32_16x16x32_bf16 v[28:31], v[52:55], v[80:83], v[28:31]
  v_mul_f32 v204, s63, v204
  v_mul_f32 v205, s63, v205
  v_mfma_f32_16x16x32_bf16 v[32:35], v[52:55], v[84:87], v[32:35]
  v_mul_f32 v206, s63, v206
  v_mul_f32 v207, s63, v207
  v_mfma_f32_16x16x32_bf16 v[36:39], v[52:55], v[88:91], v[36:39]
  v_cvt_pk_bf16_f32 v182, v204, v205
  v_cvt_pk_bf16_f32 v183, v206, v207
  v_mfma_f32_16x16x32_bf16 v[24:27], v[56:59], v[72:75], v[24:27]
  v_lshlrev_b32 v204, 16, v182
  v_and_b32 v205, 0xffff0000, v182
  v_mfma_f32_16x16x32_bf16 v[28:31], v[56:59], v[76:79], v[28:31]
  v_lshlrev_b32 v206, 16, v183
  v_and_b32 v207, 0xffff0000, v183
  v_mfma_f32_16x16x32_bf16 v[32:35], v[56:59], v[80:83], v[32:35]
  v_mfma_f32_16x16x32_bf16 v[36:39], v[56:59], v[84:87], v[36:39]
  v_mfma_f32_16x16x32_bf16 v[28:31], v[60:63], v[72:75], v[28:31]
  v_mfma_f32_16x16x32_bf16 v[32:35], v[60:63], v[76:79], v[32:35]
  v_mfma_f32_16x16x32_bf16 v[36:39], v[60:63], v[80:83], v[36:39]
  v_mfma_f32_16x16x32_bf16 v[32:35], v[64:67], v[72:75], v[32:35]
  v_mfma_f32_16x16x32_bf16 v[36:39], v[64:67], v[76:79], v[36:39]
  v_mfma_f32_16x16x32_bf16 v[36:39], v[68:71], v[72:75], v[36:39]
  s_waitcnt lgkmcnt(0)
  ds_read_b128 v[72:75], v5 offset:192
  ds_read_b64 v[40:41], v4 offset:3776
  ds_read_b64 v[42:43], v4 offset:3784
  ds_read_b128 v[76:79], v5 offset:704
  ds_read_b64 v[44:45], v4 offset:3264
  ds_read_b64 v[46:47], v4 offset:3272
  ds_read_b128 v[80:83], v5 offset:1216
  ds_read_b64 v[48:49], v4 offset:2752
  ds_read_b64 v[50:51], v4 offset:2760
  ds_read_b128 v[84:87], v5 offset:1728
  ds_read_b64 v[52:53], v4 offset:2240
  ds_read_b64 v[54:55], v4 offset:2248
  ds_read_b128 v[88:91], v5 offset:2240
  ds_read_b64 v[56:57], v4 offset:1728
  ds_read_b64 v[58:59], v4 offset:1736
  ds_read_b128 v[92:95], v5 offset:2752
  ds_read_b64 v[60:61], v4 offset:1216
  ds_read_b64 v[62:63], v4 offset:1224
  ds_read_b128 v[96:99], v5 offset:3264
  ds_read_b64 v[64:65], v4 offset:704
  ds_read_b64 v[66:67], v4 offset:712
  ds_read_b128 v[100:103], v5 offset:3776
  ds_read_b64 v[68:69], v4 offset:192
  ds_read_b64 v[70:71], v4 offset:200
  v_mfma_f32_16x16x32_bf16 v[8:11], v[104:107], v[136:139], v[8:11]
  v_mfma_f32_16x16x32_bf16 v[12:15], v[104:107], v[140:143], v[12:15]
  v_mfma_f32_16x16x32_bf16 v[16:19], v[104:107], v[144:147], v[16:19]
  v_mfma_f32_16x16x32_bf16 v[20:23], v[104:107], v[148:151], v[20:23]
  v_mfma_f32_16x16x32_bf16 v[24:27], v[104:107], v[152:155], v[24:27]
  v_mfma_f32_16x16x32_bf16 v[28:31], v[104:107], v[156:159], v[28:31]
  v_mfma_f32_16x16x32_bf16 v[32:35], v[104:107], v[160:163], v[32:35]
  v_mfma_f32_16x16x32_bf16 v[36:39], v[104:107], v[164:167], v[36:39]
  v_mfma_f32_16x16x32_bf16 v[12:15], v[108:111], v[136:139], v[12:15]
  v_mfma_f32_16x16x32_bf16 v[16:19], v[108:111], v[140:143], v[16:19]
  v_mfma_f32_16x16x32_bf16 v[20:23], v[108:111], v[144:147], v[20:23]
  v_mfma_f32_16x16x32_bf16 v[24:27], v[108:111], v[148:151], v[24:27]
  v_mfma_f32_16x16x32_bf16 v[28:31], v[108:111], v[152:155], v[28:31]
  v_mfma_f32_16x16x32_bf16 v[32:35], v[108:111], v[156:159], v[32:35]
  v_mfma_f32_16x16x32_bf16 v[36:39], v[108:111], v[160:163], v[36:39]
  v_mfma_f32_16x16x32_bf16 v[16:19], v[112:115], v[136:139], v[16:19]
  v_mfma_f32_16x16x32_bf16 v[20:23], v[112:115], v[140:143], v[20:23]
  v_mfma_f32_16x16x32_bf16 v[24:27], v[112:115], v[144:147], v[24:27]
  v_mfma_f32_16x16x32_bf16 v[28:31], v[112:115], v[148:151], v[28:31]
  v_mfma_f32_16x16x32_bf16 v[32:35], v[112:115], v[152:155], v[32:35]
  v_mfma_f32_16x16x32_bf16 v[36:39], v[112:115], v[156:159], v[36:39]
  v_mfma_f32_16x16x32_bf16 v[20:23], v[116:119], v[136:139], v[20:23]
  v_mfma_f32_16x16x32_bf16 v[24:27], v[116:119], v[140:143], v[24:27]
  v_mfma_f32_16x16x32_bf16 v[28:31], v[116:119], v[144:147], v[28:31]
  v_mfma_f32_16x16x32_bf16 v[32:35], v[116:119], v[148:151], v[32:35]
  v_mfma_f32_16x16x32_bf16 v[36:39], v[116:119], v[152:155], v[36:39]
  v_mfma_f32_16x16x32_bf16 v[24:27], v[120:123], v[136:139], v[24:27]
  v_mfma_f32_16x16x32_bf16 v[28:31], v[120:123], v[140:143], v[28:31]
  v_mfma_f32_16x16x32_bf16 v[32:35], v[120:123], v[144:147], v[32:35]
  v_mfma_f32_16x16x32_bf16 v[36:39], v[120:123], v[148:151], v[36:39]
  v_mfma_f32_16x16x32_bf16 v[28:31], v[124:127], v[136:139], v[28:31]
  v_mfma_f32_16x16x32_bf16 v[32:35], v[124:127], v[140:143], v[32:35]
  v_mfma_f32_16x16x32_bf16 v[36:39], v[124:127], v[144:147], v[36:39]
  v_mfma_f32_16x16x32_bf16 v[32:35], v[128:131], v[136:139], v[32:35]
  v_mfma_f32_16x16x32_bf16 v[36:39], v[128:131], v[140:143], v[36:39]
  v_mfma_f32_16x16x32_bf16 v[36:39], v[132:135], v[136:139], v[36:39]
  s_waitcnt lgkmcnt(0)
  ds_read_b128 v[136:139], v5 offset:64
  ds_read_b64 v[104:105], v4 offset:3648
  ds_read_b64 v[106:107], v4 offset:3656
  ds_read_b128 v[140:143], v5 offset:576
  ds_read_b64 v[108:109], v4 offset:3136
  ds_read_b64 v[110:111], v4 offset:3144
  ds_read_b128 v[144:147], v5 offset:1088
  ds_read_b64 v[112:113], v4 offset:2624
  ds_read_b64 v[114:115], v4 offset:2632
  ds_read_b128 v[148:151], v5 offset:1600
  ds_read_b64 v[116:117], v4 offset:2112
  ds_read_b64 v[118:119], v4 offset:2120
  ds_read_b128 v[152:155], v5 offset:2112
  ds_read_b64 v[120:121], v4 offset:1600
  ds_read_b64 v[122:123], v4 offset:1608
  ds_read_b128 v[156:159], v5 offset:2624
  ds_read_b64 v[124:125], v4 offset:1088
  ds_read_b64 v[126:127], v4 offset:1096
  ds_read_b128 v[160:163], v5 offset:3136
  ds_read_b64 v[128:129], v4 offset:576
  ds_read_b64 v[130:131], v4 offset:584
  ds_read_b128 v[164:167], v5 offset:3648
  ds_read_b64 v[132:133], v4 offset:64
  ds_read_b64 v[134:135], v4 offset:72
  v_mfma_f32_16x16x32_bf16 v[8:11], v[40:43], v[72:75], v[8:11]
  v_mfma_f32_16x16x32_bf16 v[12:15], v[40:43], v[76:79], v[12:15]
  v_mfma_f32_16x16x32_bf16 v[16:19], v[40:43], v[80:83], v[16:19]
  v_mfma_f32_16x16x32_bf16 v[20:23], v[40:43], v[84:87], v[20:23]
  v_mfma_f32_16x16x32_bf16 v[24:27], v[40:43], v[88:91], v[24:27]
  v_mfma_f32_16x16x32_bf16 v[28:31], v[40:43], v[92:95], v[28:31]
  v_mfma_f32_16x16x32_bf16 v[32:35], v[40:43], v[96:99], v[32:35]
  v_mfma_f32_16x16x32_bf16 v[36:39], v[40:43], v[100:103], v[36:39]
  v_mfma_f32_16x16x32_bf16 v[12:15], v[44:47], v[72:75], v[12:15]
  v_mfma_f32_16x16x32_bf16 v[16:19], v[44:47], v[76:79], v[16:19]
  v_mfma_f32_16x16x32_bf16 v[20:23], v[44:47], v[80:83], v[20:23]
  v_mfma_f32_16x16x32_bf16 v[24:27], v[44:47], v[84:87], v[24:27]
  v_mfma_f32_16x16x32_bf16 v[28:31], v[44:47], v[88:91], v[28:31]
  v_mfma_f32_16x16x32_bf16 v[32:35], v[44:47], v[92:95], v[32:35]
  v_mfma_f32_16x16x32_bf16 v[36:39], v[44:47], v[96:99], v[36:39]
  v_mfma_f32_16x16x32_bf16 v[16:19], v[48:51], v[72:75], v[16:19]
  v_mfma_f32_16x16x32_bf16 v[20:23], v[48:51], v[76:79], v[20:23]
  v_mfma_f32_16x16x32_bf16 v[24:27], v[48:51], v[80:83], v[24:27]
  v_mfma_f32_16x16x32_bf16 v[28:31], v[48:51], v[84:87], v[28:31]
  v_mfma_f32_16x16x32_bf16 v[32:35], v[48:51], v[88:91], v[32:35]
  v_mfma_f32_16x16x32_bf16 v[36:39], v[48:51], v[92:95], v[36:39]
  v_mfma_f32_16x16x32_bf16 v[20:23], v[52:55], v[72:75], v[20:23]
  v_mfma_f32_16x16x32_bf16 v[24:27], v[52:55], v[76:79], v[24:27]
  v_mfma_f32_16x16x32_bf16 v[28:31], v[52:55], v[80:83], v[28:31]
  v_mfma_f32_16x16x32_bf16 v[32:35], v[52:55], v[84:87], v[32:35]
  v_mfma_f32_16x16x32_bf16 v[36:39], v[52:55], v[88:91], v[36:39]
  v_mfma_f32_16x16x32_bf16 v[24:27], v[56:59], v[72:75], v[24:27]
  v_mfma_f32_16x16x32_bf16 v[28:31], v[56:59], v[76:79], v[28:31]
  v_mfma_f32_16x16x32_bf16 v[32:35], v[56:59], v[80:83], v[32:35]
  v_mfma_f32_16x16x32_bf16 v[36:39], v[56:59], v[84:87], v[36:39]
  v_mfma_f32_16x16x32_bf16 v[28:31], v[60:63], v[72:75], v[28:31]
  v_mfma_f32_16x16x32_bf16 v[32:35], v[60:63], v[76:79], v[32:35]
  v_mfma_f32_16x16x32_bf16 v[36:39], v[60:63], v[80:83], v[36:39]
  v_mfma_f32_16x16x32_bf16 v[32:35], v[64:67], v[72:75], v[32:35]
  v_mfma_f32_16x16x32_bf16 v[36:39], v[64:67], v[76:79], v[36:39]
  v_mfma_f32_16x16x32_bf16 v[36:39], v[68:71], v[72:75], v[36:39]
  s_setprio 3
  s_waitcnt lgkmcnt(0)
  ds_read_b64 v[40:41], v6 offset:4096
  ds_read_b64 v[42:43], v6 offset:4104
  v_add_u32 v5, s5, v7
  ds_read_b128 v[72:75], v5 offset:512
  ds_read_b128 v[76:79], v5 offset:1024
  ds_read_b128 v[80:83], v5 offset:1536
  ds_read_b128 v[84:87], v5 offset:2048
  v_mfma_f32_16x16x32_bf16 v[8:11], v[104:107], v[136:139], v[8:11]
  v_mfma_f32_16x16x32_bf16 v[12:15], v[104:107], v[140:143], v[12:15]
  v_mfma_f32_16x16x32_bf16 v[16:19], v[104:107], v[144:147], v[16:19]
  v_mfma_f32_16x16x32_bf16 v[20:23], v[104:107], v[148:151], v[20:23]
  v_mfma_f32_16x16x32_bf16 v[24:27], v[104:107], v[152:155], v[24:27]
  v_mfma_f32_16x16x32_bf16 v[28:31], v[104:107], v[156:159], v[28:31]
  v_mfma_f32_16x16x32_bf16 v[32:35], v[104:107], v[160:163], v[32:35]
  v_mfma_f32_16x16x32_bf16 v[36:39], v[104:107], v[164:167], v[36:39]
  v_mfma_f32_16x16x32_bf16 v[12:15], v[108:111], v[136:139], v[12:15]
  v_mfma_f32_16x16x32_bf16 v[16:19], v[108:111], v[140:143], v[16:19]
  v_mfma_f32_16x16x32_bf16 v[20:23], v[108:111], v[144:147], v[20:23]
  v_mfma_f32_16x16x32_bf16 v[24:27], v[108:111], v[148:151], v[24:27]
  v_mfma_f32_16x16x32_bf16 v[28:31], v[108:111], v[152:155], v[28:31]
  v_mfma_f32_16x16x32_bf16 v[32:35], v[108:111], v[156:159], v[32:35]
  v_mfma_f32_16x16x32_bf16 v[36:39], v[108:111], v[160:163], v[36:39]
  v_mfma_f32_16x16x32_bf16 v[16:19], v[112:115], v[136:139], v[16:19]
  v_mfma_f32_16x16x32_bf16 v[20:23], v[112:115], v[140:143], v[20:23]
  v_mfma_f32_16x16x32_bf16 v[24:27], v[112:115], v[144:147], v[24:27]
  v_mfma_f32_16x16x32_bf16 v[28:31], v[112:115], v[148:151], v[28:31]
  v_mfma_f32_16x16x32_bf16 v[32:35], v[112:115], v[152:155], v[32:35]
  v_mfma_f32_16x16x32_bf16 v[36:39], v[112:115], v[156:159], v[36:39]
  v_mfma_f32_16x16x32_bf16 v[20:23], v[116:119], v[136:139], v[20:23]
  v_mfma_f32_16x16x32_bf16 v[24:27], v[116:119], v[140:143], v[24:27]
  v_mfma_f32_16x16x32_bf16 v[28:31], v[116:119], v[144:147], v[28:31]
  v_mfma_f32_16x16x32_bf16 v[32:35], v[116:119], v[148:151], v[32:35]
  v_mfma_f32_16x16x32_bf16 v[36:39], v[116:119], v[152:155], v[36:39]
  v_mfma_f32_16x16x32_bf16 v[24:27], v[120:123], v[136:139], v[24:27]
  v_mfma_f32_16x16x32_bf16 v[28:31], v[120:123], v[140:143], v[28:31]
  v_mfma_f32_16x16x32_bf16 v[32:35], v[120:123], v[144:147], v[32:35]
  v_mfma_f32_16x16x32_bf16 v[36:39], v[120:123], v[148:151], v[36:39]
  v_mfma_f32_16x16x32_bf16 v[28:31], v[124:127], v[136:139], v[28:31]
  v_mfma_f32_16x16x32_bf16 v[32:35], v[124:127], v[140:143], v[32:35]
  v_mfma_f32_16x16x32_bf16 v[36:39], v[124:127], v[144:147], v[36:39]
  v_mfma_f32_16x16x32_bf16 v[32:35], v[128:131], v[136:139], v[32:35]
  v_mfma_f32_16x16x32_bf16 v[36:39], v[128:131], v[140:143], v[36:39]
  v_mfma_f32_16x16x32_bf16 v[36:39], v[132:135], v[136:139], v[36:39]
  s_setprio 3
  s_cmp_eq_u32 s61, 0
  s_cbranch_scc0 L_cv_p1
  ds_write_b128 v185, v[24:27] offset:0
  ds_write_b128 v185, v[28:31] offset:1024
  s_nop 0
  ds_write_b128 v185, v[32:35] offset:2048
  s_nop 0
  ds_write_b128 v185, v[36:39] offset:3072
  s_waitcnt lgkmcnt(4)
  v_mfma_f32_16x16x32_bf16 v[8:11], v[40:43], v[72:75], v[8:11]
  v_mfma_f32_16x16x32_bf16 v[12:15], v[40:43], v[76:79], v[12:15]
  v_mfma_f32_16x16x32_bf16 v[16:19], v[40:43], v[80:83], v[16:19]
  v_mfma_f32_16x16x32_bf16 v[20:23], v[40:43], v[84:87], v[20:23]
  s_waitcnt lgkmcnt(0)
  s_barrier
  ds_read_b128 v[40:43], v186 offset:0
  ds_read_b128 v[44:47], v186 offset:1024
  ds_read_b128 v[48:51], v186 offset:2048
  ds_read_b128 v[52:55], v186 offset:3072
  s_waitcnt lgkmcnt(3)
  v_add_f32 v8, v8, v40
  v_add_f32 v9, v9, v41
  v_add_f32 v10, v10, v42
  v_add_f32 v11, v11, v43
  v_cvt_pk_bf16_f32 v40, v8, v9
  v_cvt_pk_bf16_f32 v41, v10, v11
  v_lshlrev_b32 v8, 16, v40
  v_and_b32 v9, 0xffff0000, v40
  v_lshlrev_b32 v10, 16, v41
  v_and_b32 v11, 0xffff0000, v41
  v_add_f32 v8, v8, v192
  v_add_f32 v9, v9, v193
  v_add_f32 v10, v10, v194
  v_add_f32 v11, v11, v195
  v_cvt_pk_bf16_f32 v72, v8, v9
  v_cvt_pk_bf16_f32 v73, v10, v11
  v_xor_b32 v74, s49, v72
  v_xor_b32 v75, s49, v73
  global_store_dwordx4 v184, v[72:75], s[42:43] offset:0 sc1
  s_waitcnt lgkmcnt(2)
  v_add_f32 v12, v12, v44
  v_add_f32 v13, v13, v45
  v_add_f32 v14, v14, v46
  v_add_f32 v15, v15, v47
  v_cvt_pk_bf16_f32 v44, v12, v13
  v_cvt_pk_bf16_f32 v45, v14, v15
  v_lshlrev_b32 v12, 16, v44
  v_and_b32 v13, 0xffff0000, v44
  v_lshlrev_b32 v14, 16, v45
  v_and_b32 v15, 0xffff0000, v45
  v_add_f32 v12, v12, v196
  v_add_f32 v13, v13, v197
  v_add_f32 v14, v14, v198
  v_add_f32 v15, v15, v199
  v_cvt_pk_bf16_f32 v76, v12, v13
  v_cvt_pk_bf16_f32 v77, v14, v15
  v_xor_b32 v78, s49, v76
  v_xor_b32 v79, s49, v77
  global_store_dwordx4 v184, v[76:79], s[42:43] offset:1024 sc1
  s_waitcnt lgkmcnt(1)
  v_add_f32 v16, v16, v48
  v_add_f32 v17, v17, v49
  v_add_f32 v18, v18, v50
  v_add_f32 v19, v19, v51
  v_cvt_pk_bf16_f32 v48, v16, v17
  v_cvt_pk_bf16_f32 v49, v18, v19
  v_lshlrev_b32 v16, 16, v48
  v_and_b32 v17, 0xffff0000, v48
  v_lshlrev_b32 v18, 16, v49
  v_and_b32 v19, 0xffff0000, v49
  v_add_f32 v16, v16, v200
  v_add_f32 v17, v17, v201
  v_add_f32 v18, v18, v202
  v_add_f32 v19, v19, v203
  v_cvt_pk_bf16_f32 v80, v16, v17
  v_cvt_pk_bf16_f32 v81, v18, v19
  v_xor_b32 v82, s49, v80
  v_xor_b32 v83, s49, v81
  global_store_dwordx4 v184, v[80:83], s[42:43] offset:2048 sc1
  s_waitcnt lgkmcnt(0)
  v_add_f32 v20, v20, v52
  v_add_f32 v21, v21, v53
  v_add_f32 v22, v22, v54
  v_add_f32 v23, v23, v55
  v_cvt_pk_bf16_f32 v52, v20, v21
  v_cvt_pk_bf16_f32 v53, v22, v23
  v_lshlrev_b32 v20, 16, v52
  v_and_b32 v21, 0xffff0000, v52
  v_lshlrev_b32 v22, 16, v53
  v_and_b32 v23, 0xffff0000, v53
  v_add_f32 v20, v20, v204
  v_add_f32 v21, v21, v205
  v_add_f32 v22, v22, v206
  v_add_f32 v23, v23, v207
  v_cvt_pk_bf16_f32 v84, v20, v21
  v_cvt_pk_bf16_f32 v85, v22, v23
  v_xor_b32 v86, s49, v84
  v_xor_b32 v87, s49, v85
  global_store_dwordx4 v184, v[84:87], s[42:43] offset:3072 sc1
  s_branch L_cv_end
L_cv_p1:
  ds_write_b128 v185, v[8:11] offset:0
  ds_write_b128 v185, v[12:15] offset:1024
  ds_write_b128 v185, v[16:19] offset:2048
  ds_write_b128 v185, v[20:23] offset:3072
  s_waitcnt lgkmcnt(4)
  v_mfma_f32_16x16x32_bf16 v[24:27], v[40:43], v[72:75], v[24:27]
  v_mfma_f32_16x16x32_bf16 v[28:31], v[40:43], v[76:79], v[28:31]
  v_mfma_f32_16x16x32_bf16 v[32:35], v[40:43], v[80:83], v[32:35]
  v_mfma_f32_16x16x32_bf16 v[36:39], v[40:43], v[84:87], v[36:39]
  s_waitcnt lgkmcnt(0)
  s_barrier
  ds_read_b128 v[40:43], v186 offset:0
  ds_read_b128 v[44:47], v186 offset:1024
  ds_read_b128 v[48:51], v186 offset:2048
  ds_read_b128 v[52:55], v186 offset:3072
  s_waitcnt lgkmcnt(3)
  v_add_f32 v24, v24, v40
  v_add_f32 v25, v25, v41
  v_add_f32 v26, v26, v42
  v_add_f32 v27, v27, v43
  v_cvt_pk_bf16_f32 v40, v24, v25
  v_cvt_pk_bf16_f32 v41, v26, v27
  v_lshlrev_b32 v24, 16, v40
  v_and_b32 v25, 0xffff0000, v40
  v_lshlrev_b32 v26, 16, v41
  v_and_b32 v27, 0xffff0000, v41
  v_add_f32 v24, v24, v192
  v_add_f32 v25, v25, v193
  v_add_f32 v26, v26, v194
  v_add_f32 v27, v27, v195
  v_cvt_pk_bf16_f32 v72, v24, v25
  v_cvt_pk_bf16_f32 v73, v26, v27
  v_xor_b32 v74, s49, v72
  v_xor_b32 v75, s49, v73
  global_store_dwordx4 v184, v[72:75], s[42:43] offset:0 sc1
  s_waitcnt lgkmcnt(2)
  v_add_f32 v28, v28, v44
  v_add_f32 v29, v29, v45
  v_add_f32 v30, v30, v46
  v_add_f32 v31, v31, v47
  v_cvt_pk_bf16_f32 v44, v28, v29
  v_cvt_pk_bf16_f32 v45, v30, v31
  v_lshlrev_b32 v28, 16, v44
  v_and_b32 v29, 0xffff0000, v44
  v_lshlrev_b32 v30, 16, v45
  v_and_b32 v31, 0xffff0000, v45
  v_add_f32 v28, v28, v196
  v_add_f32 v29, v29, v197
  v_add_f32 v30, v30, v198
  v_add_f32 v31, v31, v199
  v_cvt_pk_bf16_f32 v76, v28, v29
  v_cvt_pk_bf16_f32 v77, v30, v31
  v_xor_b32 v78, s49, v76
  v_xor_b32 v79, s49, v77
  global_store_dwordx4 v184, v[76:79], s[42:43] offset:1024 sc1
  s_waitcnt lgkmcnt(1)
  v_add_f32 v32, v32, v48
  v_add_f32 v33, v33, v49
  v_add_f32 v34, v34, v50
  v_add_f32 v35, v35, v51
  v_cvt_pk_bf16_f32 v48, v32, v33
  v_cvt_pk_bf16_f32 v49, v34, v35
  v_lshlrev_b32 v32, 16, v48
  v_and_b32 v33, 0xffff0000, v48
  v_lshlrev_b32 v34, 16, v49
  v_and_b32 v35, 0xffff0000, v49
  v_add_f32 v32, v32, v200
  v_add_f32 v33, v33, v201
  v_add_f32 v34, v34, v202
  v_add_f32 v35, v35, v203
  v_cvt_pk_bf16_f32 v80, v32, v33
  v_cvt_pk_bf16_f32 v81, v34, v35
  v_xor_b32 v82, s49, v80
  v_xor_b32 v83, s49, v81
  global_store_dwordx4 v184, v[80:83], s[42:43] offset:2048 sc1
  s_waitcnt lgkmcnt(0)
  v_add_f32 v36, v36, v52
  v_add_f32 v37, v37, v53
  v_add_f32 v38, v38, v54
  v_add_f32 v39, v39, v55
  v_cvt_pk_bf16_f32 v52, v36, v37
  v_cvt_pk_bf16_f32 v53, v38, v39
  v_lshlrev_b32 v36, 16, v52
  v_and_b32 v37, 0xffff0000, v52
  v_lshlrev_b32 v38, 16, v53
  v_and_b32 v39, 0xffff0000, v53
  v_add_f32 v36, v36, v204
  v_add_f32 v37, v37, v205
  v_add_f32 v38, v38, v206
  v_add_f32 v39, v39, v207
  v_cvt_pk_bf16_f32 v84, v36, v37
  v_cvt_pk_bf16_f32 v85, v38, v39
  v_xor_b32 v86, s49, v84
  v_xor_b32 v87, s49, v85
  global_store_dwordx4 v184, v[84:87], s[42:43] offset:3072 sc1
L_cv_end:
  s_cmp_eq_u32 s46, 0
  s_cbranch_scc0 L_done
  v_lshlrev_b32 v208, 4, v0
  v_add_u32 v204, 0x60000, v208
  v_add_u32 v205, 4, v204
  v_add_u32 v206, 8, v204
  v_add_u32 v207, 12, v204
  global_load_dword v200, v204, s[42:43] sc1
  global_load_dword v201, v205, s[42:43] sc1
  global_load_dword v202, v206, s[42:43] sc1
  global_load_dword v203, v207, s[42:43] sc1
  s_waitcnt vmcnt(0)
  v_cmp_ne_u32 vcc, s49, v200
  v_cmp_ne_u32 s[4:5], s49, v201
  s_nop 0
  s_or_b64 vcc, vcc, s[4:5]
  v_cmp_ne_u32 s[4:5], s49, v202
  s_nop 0
  s_or_b64 vcc, vcc, s[4:5]
  v_cmp_ne_u32 s[4:5], s49, v203
  s_nop 0
  s_or_b64 vcc, vcc, s[4:5]
  s_cbranch_vccz L_ce_ok
  s_mov_b32 s6, 0
L_ce_spin:
  s_sleep 2
  global_load_dword v200, v204, s[42:43] sc1
  global_load_dword v201, v205, s[42:43] sc1
  global_load_dword v202, v206, s[42:43] sc1
  global_load_dword v203, v207, s[42:43] sc1
  s_add_u32 s6, s6, 1
  s_waitcnt vmcnt(0)
  v_cmp_ne_u32 vcc, s49, v200
  v_cmp_ne_u32 s[4:5], s49, v201
  s_nop 0
  s_or_b64 vcc, vcc, s[4:5]
  v_cmp_ne_u32 s[4:5], s49, v202
  s_nop 0
  s_or_b64 vcc, vcc, s[4:5]
  v_cmp_ne_u32 s[4:5], s49, v203
  s_nop 0
  s_or_b64 vcc, vcc, s[4:5]
  s_cmp_ge_u32 s6, 20000
  s_cbranch_scc1 L_ce_ok
  s_cbranch_vccnz L_ce_spin
L_ce_ok:
  s_barrier
  s_cmp_eq_u32 s45, 0
  s_cbranch_scc0 L_done
  v_add_u32 v209, 1, v214
  v_mov_b32 v208, 0
  s_mov_b64 exec, 1
  global_store_dword v208, v209, s[42:43] sc1
  s_mov_b64 exec, -1
L_done:
L_exit:
  s_endpgm
.section .rodata,"a"
.p2align 6
.amdhsa_kernel parallel_sum__ssm_conv_s4d__glu_gated_bilinear__prompt_kernel
  .amdhsa_next_free_vgpr 256
  .amdhsa_next_free_sgpr 102
  .amdhsa_accum_offset 256
  .amdhsa_group_segment_fixed_size 0
  .amdhsa_kernarg_size 112
  .amdhsa_user_sgpr_count 2
  .amdhsa_user_sgpr_kernarg_segment_ptr 1
  .amdhsa_system_sgpr_workgroup_id_x 1
.end_amdhsa_kernel
```
